```python
import torch

def _softmax(x, axis=-1):
    return torch.softmax(x, dim=axis)
def _gelu(x):
    return torch.nn.functional.gelu(x, approximate="tanh")
def _silu(x):
    return torch.nn.functional.silu(x)
def _sigmoid(x):
    return torch.sigmoid(x)
def _layernorm(x, axis=-1, eps=1e-5):
    m = x.mean(dim=axis, keepdim=True)
    v = x.var(dim=axis, keepdim=True, unbiased=False)
    return (x - m) / torch.sqrt(v + eps)
def _scatter_add(tgt, idx, src, axis=0):
    return tgt.clone().index_add_(axis, idx, src)
def _segment_sum(src, seg, n):
    out = torch.zeros((n,) + src.shape[1:], dtype=src.dtype)
    return out.index_add_(0, seg, src)
def _pad(x, pw):
    flat = tuple(v for pair in reversed(pw) for v in pair)
    return torch.nn.functional.pad(x, flat)

kernel_name = 'recurrent_scan__compressed_kv_cla__dense_activation_squared_relu__decode'

def setup_inputs():

    _w = (lambda a: (lambda t: t.to(torch.bfloat16) if t.is_floating_point() else t)(torch.as_tensor(a)))
    def _A_setup():
        B, H, Sq, Sk, D, M = 1, 16, 1, 8192, 256, 448
        Dc = 4 * D
        return {
            "x": _w((lambda *s: torch.randn(*s, dtype=torch.bfloat16) * 0.05)(B, Sq, M)),
            "c_kv": _w((lambda *s: torch.randn(*s, dtype=torch.bfloat16) * 0.8)(B, Sk, Dc)),
            "w_q": _w((lambda *s: torch.randn(*s, dtype=torch.bfloat16) * 1.6)(M, H, D) * (M ** -0.5)),
            "w_uk": _w((lambda *s: torch.randn(*s, dtype=torch.bfloat16) * 1.6)(Dc, H, D) * (Dc ** -0.5)),
            "w_uv": _w((lambda *s: torch.randn(*s, dtype=torch.bfloat16) * 0.8)(Dc, H, D) * (Dc ** -0.5)),
            "w_o": _w((lambda *s: torch.randn(*s, dtype=torch.bfloat16) * 0.8)(H, D, M) * ((H * D) ** -0.5)),
        }
    _A_in = _A_setup()

    def _B_setup():
        B, S, D, F = 1, 1, 448, 1792
        return {
            "x": _w((lambda *s: torch.randn(*s, dtype=torch.bfloat16) * 0.05)(B, S, D)),
            "w1": _w((lambda *s: torch.randn(*s, dtype=torch.bfloat16) * 0.2)(D, F)),
            "b1": _w((lambda *s: torch.randn(*s, dtype=torch.bfloat16) * 0.2)(F)),
            "w2": _w((lambda *s: torch.randn(*s, dtype=torch.bfloat16) * 0.2)(F, D)),
            "b2": _w((lambda *s: torch.randn(*s, dtype=torch.bfloat16) * 0.2)(D)),
        }
    _B_in = _B_setup()

    return {
        "A_x": _A_in["x"],
        "A_c_kv": _A_in["c_kv"],
        "A_w_q": _A_in["w_q"],
        "A_w_uk": _A_in["w_uk"],
        "A_w_uv": _A_in["w_uv"],
        "A_w_o": _A_in["w_o"],
        "B_x": _B_in["x"],
        "B_w1": _B_in["w1"],
        "B_b1": _B_in["b1"],
        "B_w2": _B_in["w2"],
        "B_b2": _B_in["b2"],
    }

def reference(A_x, A_c_kv, A_w_q, A_w_uk, A_w_uv, A_w_o, B_x, B_w1, B_b1, B_w2, B_b2):
    def _A_ref(x, c_kv, w_q, w_uk, w_uv, w_o):
        B, Sq, M = x.shape[0], x.shape[1], x.shape[2]
        Sk = c_kv.shape[1]
        H, D = w_q.shape[1], w_q.shape[2]
        q = torch.einsum("bqm,mhd->bhqd", x, w_q)
        k = torch.einsum("bkc,chd->bhkd", c_kv, w_uk)
        v = torch.einsum("bkc,chd->bhkd", c_kv, w_uv)
        scores = torch.einsum("bhqd,bhkd->bhqk", q, k) * (D ** -0.5)
        off = Sk - Sq
        qi = torch.arange(Sq)[:, None]
        kj = torch.arange(Sk)[None, :]
        cmask = kj <= (qi + off)
        scores = torch.where(cmask[None, None], scores, -1e9)
        p = _softmax(scores, axis=-1)
        ctx = torch.einsum("bhqk,bhkd->bhqd", p, v)
        return torch.einsum("bhqd,hdm->bqm", ctx, w_o)

    def _B_ref(x, w1, b1, w2, b2):
        h = torch.einsum("bsd,df->bsf", x, w1) + b1
        zero = torch.zeros_like(h)
        r = torch.where(h > zero, h, zero)
        h = r * r
        out = torch.einsum("bsf,fd->bsd", h, w2) + b2
        return out

    x = A_x
    xn = _layernorm(x, axis=-1)
    s = _A_ref(xn, A_c_kv, A_w_q, A_w_uk, A_w_uv, A_w_o)
    g = _silu(_B_ref(xn, B_w1, B_b1, B_w2, B_b2))
    return x + s * g
```

```asm
; @launch grid=(256,1,1) block=(1024,1,1) lds=110592
.amdgcn_target "amdgcn-amd-amdhsa--gfx950"
.text
.globl recurrent_scan__compressed_kv_cla__dense_activation_squared_relu__decode_kernel
.p2align 8
.type recurrent_scan__compressed_kv_cla__dense_activation_squared_relu__decode_kernel,@function
recurrent_scan__compressed_kv_cla__dense_activation_squared_relu__decode_kernel:
    s_cmp_ge_u32 s2, 256
    s_cbranch_scc1 L_end
    s_load_dwordx16 s[8:23], s[0:1], 0
    s_load_dwordx8 s[24:31], s[0:1], 64
    s_load_dwordx4 s[32:35], s[0:1], 96
    v_and_b32 v1, 63, v0
    v_lshrrev_b32 v2, 6, v0
    v_and_b32 v3, 15, v1
    v_readfirstlane_b32 s3, v2
    v_lshrrev_b32 v4, 4, v1
    s_and_b32 s4, s2, 7
    s_lshr_b32 s5, s2, 3
    s_mov_b32 s36, 0x05040100
    s_mov_b32 s37, 0x07060302
    s_mov_b32 s38, 0xff
    v_lshlrev_b32 v118, 4, v1
    v_mov_b32 v119, 0
    v_mov_b32 v100, 0
    v_mov_b32 v101, 0
    v_mov_b32 v102, 0
    v_mov_b32 v114, 0
    v_mov_b32 v72, 0
    s_cmp_ge_u32 s5, 16
    s_cbranch_scc1 L_bc
    s_lshr_b32 s7, s5, 3
    s_lshl_b32 s6, s4, 1
    s_add_u32 s6, s6, s7
    s_and_b32 s7, s5, 7
    s_cmp_ge_u32 s3, 8
    s_cbranch_scc1 L_ad_hi
    s_and_b32 s56, s3, 3
    s_lshr_b32 s57, s3, 2
    s_lshl_b32 s48, s6, 9
    s_lshl_b32 s46, s56, 7
    s_add_u32 s48, s48, s46
    s_lshl_b32 s47, s7, 1
    s_add_u32 s47, s47, s57
    s_mul_i32 s45, s47, 56
    v_lshlrev_b32 v6, 4, v4
    v_add_u32 v6, s45, v6
    v_mov_b32 v8, 0
    v_mov_b32 v9, 0
    v_mov_b32 v10, 0
    v_mov_b32 v11, 0
    v_mov_b32 v14, 0
    v_mov_b32 v15, 0
    v_mov_b32 v24, 0
    v_mov_b32 v25, 0
    v_mov_b32 v26, 0
    v_mov_b32 v27, 0
    v_mov_b32 v28, 0
    v_mov_b32 v29, 0
    v_mov_b32 v30, 0
    v_mov_b32 v31, 0
    s_mul_i32 s45, s47, 229376
    s_add_u32 s45, s45, s48
    v_lshlrev_b32 v7, 16, v4
    v_lshl_add_u32 v7, v3, 3, v7
    v_add_u32 v7, s45, v7
    v_mov_b32 v68, -1
    v_mov_b32 v69, -1
    v_mov_b32 v70, -1
    v_mov_b32 v71, -1
    s_lshl_b32 s45, s7, 3
    s_add_u32 s45, s45, s3
    s_lshl_b32 s49, s6, 6
    s_add_u32 s49, s49, s45
    s_mul_i32 s46, s49, 288
    s_add_u32 s45, s46, 0x50ee0
    v_add_u32 v5, s45, v118
    s_lshl_b32 s45, s49, 8
    s_add_u32 s45, s45, 0x128000
    s_mov_b64 exec, 0xffff
    v_add_u32 v5, s45, v118
    s_lshl_b32 s45, s49, 7
    s_add_u32 s45, s45, 0x168000
    v_writelane_b32 v5, s45, 16
    s_add_u32 s45, s45, 64
    v_writelane_b32 v5, s45, 17
    s_lshr_b32 s45, s3, 1
    s_lshl_b32 s46, s7, 2
    s_add_u32 s45, s45, s46
    s_lshl_b32 s45, s45, 10
    s_lshl_b32 s46, s6, 6
    s_add_u32 s45, s45, s46
    s_and_b32 s46, s3, 1
    s_lshl_b32 s46, s46, 5
    s_add_u32 s45, s45, s46
    s_add_u32 s45, s45, 0x1dc0
    s_mov_b32 s58, 0x0
    s_mov_b32 s59, 0x30
    s_mov_b64 exec, s[58:59]
    v_add_u32 v5, s45, v118
    s_mov_b64 exec, -1
    s_mov_b32 s58, 0xffffffff
    s_mov_b32 s59, 0x3f
    s_mov_b32 s52, 0xffffffff
    s_mov_b32 s53, 0xffffff
    s_waitcnt lgkmcnt(0)
    s_load_dword s43, s[34:35], 0
    s_mov_b64 exec, s[52:53]
    global_load_dwordx4 v[8:11], v118, s[8:9]
    s_mov_b64 exec, s[58:59]
    global_store_dwordx4 v5, v[68:71], s[34:35] sc1
    s_add_u32 s96, s34, 0x8f000
    s_addc_u32 s97, s35, 0
    s_mov_b32 s58, 0xfffc0000
    s_mov_b32 s59, 0xf
    s_mov_b64 exec, s[58:59]
    global_store_dwordx4 v5, v[68:71], s[96:97] sc1
    s_mov_b64 exec, -1
    s_mov_b32 s58, 0xffffffff
    s_mov_b32 s59, 0xffff
    global_load_dwordx2 v[12:13], v6, s[8:9]
    global_load_dwordx2 v[16:17], v7, s[12:13] nt
    v_add_u32 v7, 8192, v7
    global_load_dwordx2 v[18:19], v7, s[12:13] nt
    v_add_u32 v7, 8192, v7
    global_load_dwordx2 v[20:21], v7, s[12:13] nt
    v_add_u32 v7, 8192, v7
    global_load_dwordx2 v[22:23], v7, s[12:13] nt
    s_mov_b64 exec, s[58:59]
    global_load_dwordx2 v[14:15], v6, s[8:9] offset:8
    v_add_u32 v7, 8192, v7
    global_load_dwordx2 v[24:25], v7, s[12:13] nt
    v_add_u32 v7, 8192, v7
    global_load_dwordx2 v[26:27], v7, s[12:13] nt
    v_add_u32 v7, 8192, v7
    global_load_dwordx2 v[28:29], v7, s[12:13] nt
    v_add_u32 v7, 8192, v7
    global_load_dwordx2 v[30:31], v7, s[12:13] nt
    s_mov_b64 exec, -1
    s_barrier
    s_lshl_b32 s45, s6, 14
    s_lshl_b32 s46, s56, 12
    s_add_u32 s45, s45, s46
    s_lshl_b32 s46, s47, 6
    s_add_u32 s45, s45, s46
    s_add_u32 s45, s45, 0x11000
    v_lshrrev_b32 v5, 3, v3
    v_lshlrev_b32 v5, 11, v5
    v_and_b32 v6, 1, v3
    v_lshl_add_u32 v5, v6, 10, v5
    v_bfe_u32 v6, v3, 1, 2
    v_lshl_add_u32 v5, v6, 4, v5
    v_add_u32 v5, s45, v5
    s_waitcnt lgkmcnt(0)
    s_add_u32 s43, s43, 0x01010101
    s_and_b32 s45, s43, 0xff
    v_mov_b32 v120, s45
    s_bfe_u32 s45, s43, 0x80008
    v_mov_b32 v121, s45
    s_bfe_u32 s45, s43, 0x80010
    v_mov_b32 v122, s45
    s_lshr_b32 s45, s43, 24
    v_mov_b32 v123, s45
    s_waitcnt vmcnt(12)
    v_lshlrev_b32 v72, 16, v8
    v_and_b32 v73, 0xffff0000, v8
    v_lshlrev_b32 v74, 16, v9
    v_and_b32 v75, 0xffff0000, v9
    v_lshlrev_b32 v76, 16, v10
    v_and_b32 v77, 0xffff0000, v10
    v_lshlrev_b32 v78, 16, v11
    v_and_b32 v79, 0xffff0000, v11
    v_add_f32 v80, v72, v73
    v_add_f32 v81, v74, v75
    v_add_f32 v82, v76, v77
    v_add_f32 v83, v78, v79
    v_add_f32 v80, v80, v81
    v_add_f32 v82, v82, v83
    v_add_f32 v80, v80, v82
    s_nop 1
    v_add_f32_dpp v80, v80, v80 row_shr:1 row_mask:0xf bank_mask:0xf bound_ctrl:0
    s_nop 1
    v_add_f32_dpp v80, v80, v80 row_shr:2 row_mask:0xf bank_mask:0xf bound_ctrl:0
    s_nop 1
    v_add_f32_dpp v80, v80, v80 row_shr:4 row_mask:0xf bank_mask:0xf bound_ctrl:0
    s_nop 1
    v_add_f32_dpp v80, v80, v80 row_shr:8 row_mask:0xf bank_mask:0xf bound_ctrl:0
    s_nop 1
    v_add_f32_dpp v80, v80, v80 row_bcast:15 row_mask:0xa bank_mask:0xf
    s_nop 1
    v_add_f32_dpp v80, v80, v80 row_bcast:31 row_mask:0xc bank_mask:0xf
    s_nop 0
    v_readlane_b32 s45, v80, 63
    s_nop 1
    v_mov_b32 v81, 0x3b124925
    v_mul_f32 v84, s45, v81
    v_mov_b32 v80, 0
    v_mov_b32 v82, 0
    s_mov_b64 exec, s[52:53]
    v_sub_f32 v72, v72, v84
    v_sub_f32 v73, v73, v84
    v_sub_f32 v74, v74, v84
    v_sub_f32 v75, v75, v84
    v_sub_f32 v76, v76, v84
    v_sub_f32 v77, v77, v84
    v_sub_f32 v78, v78, v84
    v_sub_f32 v79, v79, v84
    v_fmac_f32 v80, v72, v72
    v_fmac_f32 v82, v73, v73
    v_fmac_f32 v80, v74, v74
    v_fmac_f32 v82, v75, v75
    v_fmac_f32 v80, v76, v76
    v_fmac_f32 v82, v77, v77
    v_fmac_f32 v80, v78, v78
    v_fmac_f32 v82, v79, v79
    v_add_f32 v80, v80, v82
    s_mov_b64 exec, -1
    s_nop 1
    v_add_f32_dpp v80, v80, v80 row_shr:1 row_mask:0xf bank_mask:0xf bound_ctrl:0
    s_nop 1
    v_add_f32_dpp v80, v80, v80 row_shr:2 row_mask:0xf bank_mask:0xf bound_ctrl:0
    s_nop 1
    v_add_f32_dpp v80, v80, v80 row_shr:4 row_mask:0xf bank_mask:0xf bound_ctrl:0
    s_nop 1
    v_add_f32_dpp v80, v80, v80 row_shr:8 row_mask:0xf bank_mask:0xf bound_ctrl:0
    s_nop 1
    v_add_f32_dpp v80, v80, v80 row_bcast:15 row_mask:0xa bank_mask:0xf
    s_nop 1
    v_add_f32_dpp v80, v80, v80 row_bcast:31 row_mask:0xc bank_mask:0xf
    s_nop 0
    v_readlane_b32 s45, v80, 63
    s_nop 1
    v_mul_f32 v85, s45, v81
    v_cvt_pk_bf16_f32 v86, v84, v85
    v_lshlrev_b32 v84, 16, v86
    v_and_b32 v85, 0xffff0000, v86
    v_add_f32 v85, 0x3727c5ac, v85
    v_cvt_pk_bf16_f32 v86, v85, v85
    v_lshlrev_b32 v85, 16, v86
    v_sqrt_f32 v85, v85
    s_nop 0
    v_cvt_pk_bf16_f32 v86, v85, v85
    v_lshlrev_b32 v85, 16, v86
    v_rcp_f32 v86, v85
    v_readfirstlane_b32 s40, v84
    v_readfirstlane_b32 s41, v85
    v_readfirstlane_b32 s42, v86
    s_nop 1
    s_waitcnt vmcnt(4)
    v_lshlrev_b32 v72, 16, v12
    v_and_b32 v73, 0xffff0000, v12
    v_lshlrev_b32 v74, 16, v13
    v_and_b32 v75, 0xffff0000, v13
    v_lshlrev_b32 v76, 16, v14
    v_and_b32 v77, 0xffff0000, v14
    v_lshlrev_b32 v78, 16, v15
    v_and_b32 v79, 0xffff0000, v15
    v_subrev_f32 v72, s40, v72
    v_subrev_f32 v73, s40, v73
    v_subrev_f32 v74, s40, v74
    v_subrev_f32 v75, s40, v75
    v_subrev_f32 v76, s40, v76
    v_subrev_f32 v77, s40, v77
    v_subrev_f32 v78, s40, v78
    v_subrev_f32 v79, s40, v79
    v_cvt_pk_bf16_f32 v80, v72, v73
    v_lshlrev_b32 v72, 16, v80
    v_and_b32 v73, 0xffff0000, v80
    v_cvt_pk_bf16_f32 v80, v74, v75
    v_lshlrev_b32 v74, 16, v80
    v_and_b32 v75, 0xffff0000, v80
    v_cvt_pk_bf16_f32 v80, v76, v77
    v_lshlrev_b32 v76, 16, v80
    v_and_b32 v77, 0xffff0000, v80
    v_cvt_pk_bf16_f32 v80, v78, v79
    v_lshlrev_b32 v78, 16, v80
    v_and_b32 v79, 0xffff0000, v80
    v_mul_f32 v80, s42, v72
    v_fma_f32 v81, -v80, s41, v72
    v_fma_f32 v72, v81, s42, v80
    v_mul_f32 v80, s42, v73
    v_fma_f32 v81, -v80, s41, v73
    v_fma_f32 v73, v81, s42, v80
    v_mul_f32 v80, s42, v74
    v_fma_f32 v81, -v80, s41, v74
    v_fma_f32 v74, v81, s42, v80
    v_mul_f32 v80, s42, v75
    v_fma_f32 v81, -v80, s41, v75
    v_fma_f32 v75, v81, s42, v80
    v_mul_f32 v80, s42, v76
    v_fma_f32 v81, -v80, s41, v76
    v_fma_f32 v76, v81, s42, v80
    v_mul_f32 v80, s42, v77
    v_fma_f32 v81, -v80, s41, v77
    v_fma_f32 v77, v81, s42, v80
    v_mul_f32 v80, s42, v78
    v_fma_f32 v81, -v80, s41, v78
    v_fma_f32 v78, v81, s42, v80
    v_mul_f32 v80, s42, v79
    v_fma_f32 v81, -v80, s41, v79
    v_fma_f32 v79, v81, s42, v80
    v_cvt_pk_bf16_f32 v88, v72, v73
    v_cvt_pk_bf16_f32 v89, v74, v75
    v_cvt_pk_bf16_f32 v90, v76, v77
    v_cvt_pk_bf16_f32 v91, v78, v79
    s_waitcnt vmcnt(0)
    v_perm_b32 v72, v18, v16, s36
    v_perm_b32 v73, v22, v20, s36
    v_perm_b32 v74, v26, v24, s36
    v_perm_b32 v75, v30, v28, s36
    v_perm_b32 v76, v18, v16, s37
    v_perm_b32 v77, v22, v20, s37
    v_perm_b32 v78, v26, v24, s37
    v_perm_b32 v79, v30, v28, s37
    v_perm_b32 v80, v19, v17, s36
    v_perm_b32 v81, v23, v21, s36
    v_perm_b32 v82, v27, v25, s36
    v_perm_b32 v83, v31, v29, s36
    v_perm_b32 v84, v19, v17, s37
    v_perm_b32 v85, v23, v21, s37
    v_perm_b32 v86, v27, v25, s37
    v_perm_b32 v87, v31, v29, s37
    s_nop 1
    v_mfma_f32_16x16x32_bf16 v[92:95], v[88:91], v[72:75], 0
    v_mfma_f32_16x16x32_bf16 v[96:99], v[88:91], v[76:79], 0
    v_mfma_f32_16x16x32_bf16 v[100:103], v[88:91], v[80:83], 0
    v_mfma_f32_16x16x32_bf16 v[104:107], v[88:91], v[84:87], 0
    s_nop 7
    v_bfi_b32 v108, s38, v120, v92
    v_bfi_b32 v109, s38, v121, v96
    v_bfi_b32 v110, s38, v122, v100
    v_bfi_b32 v111, s38, v123, v104
    s_mov_b64 exec, 0xffff
    global_store_dwordx4 v5, v[108:111], s[34:35]
    global_store_dwordx4 v5, v[108:111], s[96:97] sc1
    s_mov_b64 exec, -1
    s_lshl_b32 s45, s6, 7
    s_lshl_b32 s46, s7, 2
    s_add_u32 s45, s45, s46
    s_add_u32 s45, s45, 0x1000
    v_mov_b32 v114, s45
    v_mov_b32 v115, s43
    s_barrier
    s_cmp_lg_u32 s3, 0
    s_cbranch_scc1 L_ad_b0
    s_mov_b64 exec, 1
    global_store_dword v114, v115, s[34:35] sc1
    s_mov_b64 exec, -1
    s_branch L_ad_b0
L_ad_hi:
    s_sub_u32 s54, s3, 8
    s_lshl_b32 s45, s7, 20
    s_lshl_b32 s46, s54, 17
    s_add_u32 s45, s45, s46
    s_lshl_b32 s46, s6, 9
    s_add_u32 s45, s45, s46
    v_and_b32 v5, 7, v3
    v_lshlrev_b32 v5, 13, v5
    v_lshrrev_b32 v6, 3, v3
    v_lshl_add_u32 v5, v6, 6, v5
    v_lshl_add_u32 v5, v4, 4, v5
    v_add_u32 v5, s45, v5
    v_add_u32 v6, 65536, v5
    s_lshr_b32 s45, s54, 1
    s_lshl_b32 s46, s7, 2
    s_add_u32 s45, s45, s46
    s_lshl_b32 s45, s45, 10
    s_lshl_b32 s46, s6, 6
    s_add_u32 s45, s45, s46
    s_and_b32 s46, s54, 1
    s_lshl_b32 s46, s46, 5
    s_add_u32 s45, s45, s46
    s_add_u32 s45, s45, 0x2000
    v_lshlrev_b32 v119, 1, v3
    v_add_u32 v119, s45, v119
    s_waitcnt lgkmcnt(0)
    s_load_dword s43, s[34:35], 0
    s_barrier
    global_load_dwordx4 v[36:39], v5, s[14:15] offset:0 nt
    global_load_dwordx4 v[44:47], v5, s[14:15] offset:128 nt
    global_load_dwordx4 v[52:55], v5, s[14:15] offset:256 nt
    global_load_dwordx4 v[60:63], v5, s[14:15] offset:384 nt
    global_load_dwordx4 v[40:43], v6, s[14:15] offset:0 nt
    global_load_dwordx4 v[48:51], v6, s[14:15] offset:128 nt
    global_load_dwordx4 v[56:59], v6, s[14:15] offset:256 nt
    global_load_dwordx4 v[64:67], v6, s[14:15] offset:384 nt
    s_waitcnt lgkmcnt(0)
    s_add_u32 s43, s43, 0x01010101
    s_and_b32 s45, s43, 0xff
    v_mov_b32 v120, s45
    s_bfe_u32 s45, s43, 0x80008
    v_mov_b32 v121, s45
    s_bfe_u32 s45, s43, 0x80010
    v_mov_b32 v122, s45
    s_lshr_b32 s45, s43, 24
    v_mov_b32 v123, s45
    s_add_u32 s96, s34, 0x8f000
    s_addc_u32 s97, s35, 0
    s_barrier
    s_waitcnt vmcnt(0)
L_ad_b0:
    s_lshl_b32 s45, s6, 14
    s_lshl_b32 s46, s3, 10
    s_add_u32 s45, s45, s46
    s_add_u32 s45, s45, 0x11000
    v_lshlrev_b32 v116, 6, v3
    v_lshl_add_u32 v116, v4, 4, v116
    v_add_u32 v116, s45, v116
    s_lshr_b32 s45, s3, 1
    s_lshl_b32 s45, s45, 10
    s_and_b32 s46, s3, 1
    s_lshl_b32 s46, s46, 3
    s_add_u32 s45, s45, s46
    v_add_u32 v117, s45, v118
    s_cmp_lt_u32 s3, 8
    s_cbranch_scc1 L_ad_s2
    v_mov_b32 v108, v40
    v_mov_b32 v109, v41
    v_mov_b32 v110, v42
    v_mov_b32 v111, v43
    v_mov_b32_dpp v40, v36 row_ror:8 row_mask:0xf bank_mask:0x3
    v_mov_b32_dpp v41, v37 row_ror:8 row_mask:0xf bank_mask:0x3
    v_mov_b32_dpp v42, v38 row_ror:8 row_mask:0xf bank_mask:0x3
    v_mov_b32_dpp v43, v39 row_ror:8 row_mask:0xf bank_mask:0x3
    v_mov_b32_dpp v36, v108 row_ror:8 row_mask:0xf bank_mask:0xc
    v_mov_b32_dpp v37, v109 row_ror:8 row_mask:0xf bank_mask:0xc
    v_mov_b32_dpp v38, v110 row_ror:8 row_mask:0xf bank_mask:0xc
    v_mov_b32_dpp v39, v111 row_ror:8 row_mask:0xf bank_mask:0xc
    v_mov_b32 v108, v48
    v_mov_b32 v109, v49
    v_mov_b32 v110, v50
    v_mov_b32 v111, v51
    v_mov_b32_dpp v48, v44 row_ror:8 row_mask:0xf bank_mask:0x3
    v_mov_b32_dpp v49, v45 row_ror:8 row_mask:0xf bank_mask:0x3
    v_mov_b32_dpp v50, v46 row_ror:8 row_mask:0xf bank_mask:0x3
    v_mov_b32_dpp v51, v47 row_ror:8 row_mask:0xf bank_mask:0x3
    v_mov_b32_dpp v44, v108 row_ror:8 row_mask:0xf bank_mask:0xc
    v_mov_b32_dpp v45, v109 row_ror:8 row_mask:0xf bank_mask:0xc
    v_mov_b32_dpp v46, v110 row_ror:8 row_mask:0xf bank_mask:0xc
    v_mov_b32_dpp v47, v111 row_ror:8 row_mask:0xf bank_mask:0xc
    v_mov_b32 v108, v56
    v_mov_b32 v109, v57
    v_mov_b32 v110, v58
    v_mov_b32 v111, v59
    v_mov_b32_dpp v56, v52 row_ror:8 row_mask:0xf bank_mask:0x3
    v_mov_b32_dpp v57, v53 row_ror:8 row_mask:0xf bank_mask:0x3
    v_mov_b32_dpp v58, v54 row_ror:8 row_mask:0xf bank_mask:0x3
    v_mov_b32_dpp v59, v55 row_ror:8 row_mask:0xf bank_mask:0x3
    v_mov_b32_dpp v52, v108 row_ror:8 row_mask:0xf bank_mask:0xc
    v_mov_b32_dpp v53, v109 row_ror:8 row_mask:0xf bank_mask:0xc
    v_mov_b32_dpp v54, v110 row_ror:8 row_mask:0xf bank_mask:0xc
    v_mov_b32_dpp v55, v111 row_ror:8 row_mask:0xf bank_mask:0xc
    v_mov_b32 v108, v64
    v_mov_b32 v109, v65
    v_mov_b32 v110, v66
    v_mov_b32 v111, v67
    v_mov_b32_dpp v64, v60 row_ror:8 row_mask:0xf bank_mask:0x3
    v_mov_b32_dpp v65, v61 row_ror:8 row_mask:0xf bank_mask:0x3
    v_mov_b32_dpp v66, v62 row_ror:8 row_mask:0xf bank_mask:0x3
    v_mov_b32_dpp v67, v63 row_ror:8 row_mask:0xf bank_mask:0x3
    v_mov_b32_dpp v60, v108 row_ror:8 row_mask:0xf bank_mask:0xc
    v_mov_b32_dpp v61, v109 row_ror:8 row_mask:0xf bank_mask:0xc
    v_mov_b32_dpp v62, v110 row_ror:8 row_mask:0xf bank_mask:0xc
    v_mov_b32_dpp v63, v111 row_ror:8 row_mask:0xf bank_mask:0xc
L_ad_s2:
    s_barrier
    global_load_dwordx4 v[72:75], v116, s[34:35] sc1
    s_mov_b32 s44, 0
    s_waitcnt vmcnt(0)
    s_branch Lpchk_2
Lpoll_1:
    s_and_b32 s45, s44, 15
    s_cmp_eq_u32 s45, 15
    s_cselect_b64 s[98:99], s[96:97], s[34:35]
    global_load_dwordx4 v[72:75], v116, s[98:99] sc1
    s_waitcnt vmcnt(0)
Lpchk_2:
    v_xor_b32 v112, v72, v120
    v_bitop3_b32 v112, v112, v73, v121 bitop3:0xf6
    v_bitop3_b32 v112, v112, v74, v122 bitop3:0xf6
    v_bitop3_b32 v112, v112, v75, v123 bitop3:0xf6
    v_and_b32 v112, 0xff, v112
    v_cmp_ne_u32 s[50:51], 0, v112
    s_add_u32 s44, s44, 1
    s_cmp_eq_u64 s[50:51], 0
    s_cbranch_scc1 Lpdone_3
    s_cmp_lt_u32 s44, 100000
    s_cbranch_scc1 Lpoll_1
    v_mov_b32 v112, 4
    v_mov_b32 v2, s2
    v_add_u32 v2, 0x10000, v2
    global_store_dword v112, v2, s[32:33]
Lpdone_3:
    v_add_f32_dpp v72, v72, v72 row_ror:8 row_mask:0xf bank_mask:0xf
    v_add_f32_dpp v73, v73, v73 row_ror:8 row_mask:0xf bank_mask:0xf
    v_add_f32_dpp v74, v74, v74 row_ror:8 row_mask:0xf bank_mask:0xf
    v_add_f32_dpp v75, v75, v75 row_ror:8 row_mask:0xf bank_mask:0xf
    v_add_f32_dpp v72, v72, v72 row_ror:4 row_mask:0xf bank_mask:0xf
    v_add_f32_dpp v73, v73, v73 row_ror:4 row_mask:0xf bank_mask:0xf
    v_add_f32_dpp v74, v74, v74 row_ror:4 row_mask:0xf bank_mask:0xf
    v_add_f32_dpp v75, v75, v75 row_ror:4 row_mask:0xf bank_mask:0xf
    v_add_f32_dpp v72, v72, v72 row_ror:2 row_mask:0xf bank_mask:0xf
    v_add_f32_dpp v73, v73, v73 row_ror:2 row_mask:0xf bank_mask:0xf
    v_add_f32_dpp v74, v74, v74 row_ror:2 row_mask:0xf bank_mask:0xf
    v_add_f32_dpp v75, v75, v75 row_ror:2 row_mask:0xf bank_mask:0xf
    v_add_f32_dpp v72, v72, v72 row_ror:1 row_mask:0xf bank_mask:0xf
    v_add_f32_dpp v73, v73, v73 row_ror:1 row_mask:0xf bank_mask:0xf
    v_add_f32_dpp v74, v74, v74 row_ror:1 row_mask:0xf bank_mask:0xf
    v_add_f32_dpp v75, v75, v75 row_ror:1 row_mask:0xf bank_mask:0xf
    v_cvt_pk_bf16_f32 v76, v72, v73
    v_cvt_pk_bf16_f32 v77, v74, v75
    ds_write_b64 v117, v[76:77] offset:0
    s_waitcnt lgkmcnt(0)
    s_barrier
    s_and_b32 s56, s7, 3
    s_lshr_b32 s57, s7, 2
    s_cmp_lt_u32 s3, 8
    s_cbranch_scc1 L_ad_dlo
    ds_read_b128 v[72:75], v118 offset:0
    ds_read_b128 v[76:79], v118 offset:1024
    ds_read_b128 v[80:83], v118 offset:2048
    ds_read_b128 v[84:87], v118 offset:3072
    ds_read_b128 v[88:91], v118 offset:4096
    ds_read_b128 v[92:95], v118 offset:5120
    ds_read_b128 v[96:99], v118 offset:6144
    ds_read_b128 v[100:103], v118 offset:7168
    s_waitcnt lgkmcnt(7)
    v_mfma_f32_16x16x32_bf16 v[104:107], v[72:75], v[36:39], 0
    s_waitcnt lgkmcnt(6)
    v_mfma_f32_16x16x32_bf16 v[108:111], v[76:79], v[40:43], 0
    s_waitcnt lgkmcnt(5)
    v_mfma_f32_16x16x32_bf16 v[104:107], v[80:83], v[44:47], v[104:107]
    s_waitcnt lgkmcnt(4)
    v_mfma_f32_16x16x32_bf16 v[108:111], v[84:87], v[48:51], v[108:111]
    s_waitcnt lgkmcnt(3)
    v_mfma_f32_16x16x32_bf16 v[104:107], v[88:91], v[52:55], v[104:107]
    s_waitcnt lgkmcnt(2)
    v_mfma_f32_16x16x32_bf16 v[108:111], v[92:95], v[56:59], v[108:111]
    s_waitcnt lgkmcnt(1)
    v_mfma_f32_16x16x32_bf16 v[104:107], v[96:99], v[60:63], v[104:107]
    s_waitcnt lgkmcnt(0)
    v_mfma_f32_16x16x32_bf16 v[108:111], v[100:103], v[64:67], v[108:111]
    s_nop 7
    v_add_f32 v104, v104, v108
    s_nop 1
    v_mov_b32_dpp v105, v104 quad_perm:[1,1,3,3] row_mask:0xf bank_mask:0xf
    v_cvt_pk_bf16_f32 v104, v104, v105
    v_min_u32 v104, 0xfffffffe, v104
    s_nop 1
    v_mov_b32_dpp v105, v104 row_shl:2 row_mask:0xf bank_mask:0xf
    v_mov_b32_dpp v106, v104 row_shl:4 row_mask:0xf bank_mask:0xf
    v_mov_b32_dpp v107, v104 row_shl:6 row_mask:0xf bank_mask:0xf
    s_mov_b64 exec, 0x0101
    global_store_dwordx4 v119, v[104:107], s[34:35] sc1
    s_mov_b64 exec, -1
    s_barrier
    s_cmp_ge_u32 s3, 15
    s_cbranch_scc1 L_end
    s_lshl_b32 s45, s6, 8
    s_lshl_b32 s46, s56, 6
    s_add_u32 s45, s45, s46
    s_mul_i32 s45, s45, 896
    s_lshl_b32 s46, s54, 7
    s_add_u32 s45, s45, s46
    v_lshrrev_b32 v5, 3, v3
    v_lshl_add_u32 v5, v5, 2, v4
    v_mul_u32_u24 v5, 7168, v5
    v_and_b32 v6, 7, v3
    v_lshl_add_u32 v5, v6, 4, v5
    v_add_u32 v5, s45, v5
    v_add_u32 v6, 3584, v5
    global_load_dwordx4 v[8:11], v5, s[18:19] offset:0
    global_load_dwordx4 v[12:15], v5, s[18:19] offset:896
    global_load_dwordx4 v[16:19], v5, s[18:19] offset:1792
    global_load_dwordx4 v[20:23], v5, s[18:19] offset:2688
    global_load_dwordx4 v[24:27], v6, s[18:19] offset:0
    global_load_dwordx4 v[28:31], v6, s[18:19] offset:896
    global_load_dwordx4 v[32:35], v6, s[18:19] offset:1792
    global_load_dwordx4 v[36:39], v6, s[18:19] offset:2688
    v_and_b32 v6, 7, v3
    v_mul_u32_u24 v6, 144, v6
    v_lshl_add_u32 v6, v4, 4, v6
    s_lshl_b32 s45, s4, 4
    s_add_u32 s45, s45, s5
    s_mul_i32 s45, s45, 1792
    s_lshl_b32 s46, s54, 8
    s_add_u32 s45, s45, s46
    s_add_u32 s45, s45, 0x1c0000
    v_and_b32 v100, 7, v3
    v_lshlrev_b32 v100, 3, v100
    v_lshrrev_b32 v101, 3, v3
    v_lshl_add_u32 v100, v101, 2, v100
    v_lshlrev_b32 v100, 2, v100
    v_add_u32 v100, s45, v100
    v_lshlrev_b32 v101, 3, v4
    v_lshrrev_b32 v101, v101, s43
    s_mov_b32 s52, 0x0
    s_mov_b32 s53, 0xffffffff
    s_branch L_ad_mlp
L_ad_hipost:
    s_barrier
    ds_read_b128 v[72:75], v6 offset:8192
    ds_read_b128 v[76:79], v6 offset:8256
    s_waitcnt lgkmcnt(1)
    v_mfma_f32_16x16x32_bf16 v[80:83], v[72:75], v[40:43], 0
    v_mfma_f32_16x16x32_bf16 v[84:87], v[72:75], v[44:47], 0
    v_mfma_f32_16x16x32_bf16 v[88:91], v[72:75], v[48:51], 0
    v_mfma_f32_16x16x32_bf16 v[92:95], v[72:75], v[52:55], 0
    s_waitcnt lgkmcnt(0)
    v_mfma_f32_16x16x32_bf16 v[80:83], v[76:79], v[56:59], v[80:83]
    v_mfma_f32_16x16x32_bf16 v[84:87], v[76:79], v[60:63], v[84:87]
    v_mfma_f32_16x16x32_bf16 v[88:91], v[76:79], v[64:67], v[88:91]
    v_mfma_f32_16x16x32_bf16 v[92:95], v[76:79], v[68:71], v[92:95]
    s_nop 4
    v_add_f32 v80, v80, v81
    v_add_f32 v82, v82, v83
    v_add_f32 v80, v80, v82
    v_add_f32 v84, v84, v85
    v_add_f32 v86, v86, v87
    v_add_f32 v84, v84, v86
    v_add_f32 v88, v88, v89
    v_add_f32 v90, v90, v91
    v_add_f32 v88, v88, v90
    v_add_f32 v92, v92, v93
    v_add_f32 v94, v94, v95
    v_add_f32 v92, v92, v94
    v_mov_b32 v81, v80
    v_mov_b32 v85, v84
    v_mov_b32 v89, v88
    v_mov_b32 v93, v92
    v_permlane16_swap_b32 v80, v81
    v_permlane16_swap_b32 v84, v85
    v_permlane16_swap_b32 v88, v89
    v_permlane16_swap_b32 v92, v93
    v_add_f32 v80, v80, v81
    v_add_f32 v84, v84, v85
    v_add_f32 v88, v88, v89
    v_add_f32 v92, v92, v93
    v_bfi_b32 v72, s38, v120, v80
    v_bfi_b32 v73, s38, v121, v84
    v_bfi_b32 v74, s38, v122, v88
    v_bfi_b32 v75, s38, v123, v92
    s_mov_b64 exec, 0xffff
    global_store_dwordx4 v100, v[72:75], s[34:35] sc1
    s_mov_b64 exec, -1
    s_cmp_lg_u32 s3, 14
    s_cbranch_scc1 L_ad_end
    s_lshl_b32 s45, s4, 4
    s_add_u32 s45, s45, s5
    s_lshl_b32 s45, s45, 6
    s_add_u32 s45, s45, 0x1fa000
    v_mov_b32 v8, s45
    v_mov_b32 v9, s43
    s_mov_b64 exec, 1
    global_store_dword v8, v9, s[34:35]
    s_mov_b64 exec, -1
    s_branch L_ad_end
L_ad_dlo:
    s_lshl_b32 s47, s57, 3
    s_add_u32 s47, s47, s3
    s_lshl_b32 s45, s47, 19
    s_lshl_b32 s46, s6, 9
    s_add_u32 s45, s45, s46
    s_lshl_b32 s46, s56, 7
    s_add_u32 s45, s45, s46
    v_and_b32 v7, 1, v4
    v_lshlrev_b32 v7, 2, v7
    v_lshrrev_b32 v6, 1, v4
    v_add_u32 v7, v7, v6
    v_lshrrev_b32 v6, 3, v3
    v_lshl_add_u32 v7, v6, 1, v7
    v_lshlrev_b32 v7, 13, v7
    v_and_b32 v6, 7, v3
    v_lshl_add_u32 v7, v6, 4, v7
    v_add_u32 v7, s45, v7
    s_lshl_b32 s45, s6, 4
    s_add_u32 s45, s45, s47
    s_lshl_b32 s46, s45, 10
    s_add_u32 s46, s46, 0x128000
    v_lshlrev_b32 v101, 7, v3
    v_lshl_add_u32 v101, v4, 4, v101
    v_add_u32 v101, s46, v101
    s_lshl_b32 s46, s45, 9
    s_add_u32 s46, s46, 0x168000
    v_and_b32 v102, 1, v4
    v_and_b32 v6, 3, v3
    v_lshl_add_u32 v102, v102, 2, v6
    v_lshlrev_b32 v102, 6, v102
    v_add_u32 v102, s46, v102
    v_mov_b32 v72, 0
    v_mov_b32 v73, 0
    v_mov_b32 v74, 0
    v_mov_b32 v75, 0
    v_mov_b32 v76, 0
    v_mov_b32 v77, 0
    v_mov_b32 v78, 0
    v_mov_b32 v79, 0
    s_mov_b32 s52, 0xff00ff
    s_mov_b32 s53, 0xff00ff
    s_mul_i32 s45, s3, 144
    v_and_b32 v5, 7, v3
    v_lshlrev_b32 v5, 3, v5
    v_lshrrev_b32 v6, 3, v3
    v_lshl_add_u32 v5, v6, 2, v5
    v_add_u32 v5, v5, v4
    v_lshlrev_b32 v5, 1, v5
    v_add_u32 v5, s45, v5
    s_barrier
    global_load_dwordx4 v[8:11], v7, s[16:17] nt
    v_add_u32 v7, 65536, v7
    global_load_dwordx4 v[12:15], v7, s[16:17] nt
    v_add_u32 v7, 65536, v7
    global_load_dwordx4 v[16:19], v7, s[16:17] nt
    v_add_u32 v7, 65536, v7
    global_load_dwordx4 v[20:23], v7, s[16:17] nt
    v_add_u32 v7, 65536, v7
    global_load_dwordx4 v[24:27], v7, s[16:17] nt
    v_add_u32 v7, 65536, v7
    global_load_dwordx4 v[28:31], v7, s[16:17] nt
    v_add_u32 v7, 65536, v7
    global_load_dwordx4 v[32:35], v7, s[16:17] nt
    v_add_u32 v7, 65536, v7
    global_load_dwordx4 v[36:39], v7, s[16:17] nt
L_ad_mlp:
    s_waitcnt vmcnt(0)
    v_perm_b32 v40, v12, v8, s36
    v_perm_b32 v41, v20, v16, s36
    v_perm_b32 v42, v28, v24, s36
    v_perm_b32 v43, v36, v32, s36
    v_perm_b32 v44, v12, v8, s37
    v_perm_b32 v45, v20, v16, s37
    v_perm_b32 v46, v28, v24, s37
    v_perm_b32 v47, v36, v32, s37
    v_perm_b32 v48, v13, v9, s36
    v_perm_b32 v49, v21, v17, s36
    v_perm_b32 v50, v29, v25, s36
    v_perm_b32 v51, v37, v33, s36
    v_perm_b32 v52, v13, v9, s37
    v_perm_b32 v53, v21, v17, s37
    v_perm_b32 v54, v29, v25, s37
    v_perm_b32 v55, v37, v33, s37
    v_perm_b32 v56, v14, v10, s36
    v_perm_b32 v57, v22, v18, s36
    v_perm_b32 v58, v30, v26, s36
    v_perm_b32 v59, v38, v34, s36
    v_perm_b32 v60, v14, v10, s37
    v_perm_b32 v61, v22, v18, s37
    v_perm_b32 v62, v30, v26, s37
    v_perm_b32 v63, v38, v34, s37
    v_perm_b32 v64, v15, v11, s36
    v_perm_b32 v65, v23, v19, s36
    v_perm_b32 v66, v31, v27, s36
    v_perm_b32 v67, v39, v35, s36
    v_perm_b32 v68, v15, v11, s37
    v_perm_b32 v69, v23, v19, s37
    v_perm_b32 v70, v31, v27, s37
    v_perm_b32 v71, v39, v35, s37
    v_mov_b32 v108, v56
    v_mov_b32 v109, v57
    v_mov_b32 v110, v58
    v_mov_b32 v111, v59
    v_mov_b32_dpp v56, v40 row_ror:8 row_mask:0xf bank_mask:0x3
    v_mov_b32_dpp v57, v41 row_ror:8 row_mask:0xf bank_mask:0x3
    v_mov_b32_dpp v58, v42 row_ror:8 row_mask:0xf bank_mask:0x3
    v_mov_b32_dpp v59, v43 row_ror:8 row_mask:0xf bank_mask:0x3
    v_mov_b32_dpp v40, v108 row_ror:8 row_mask:0xf bank_mask:0xc
    v_mov_b32_dpp v41, v109 row_ror:8 row_mask:0xf bank_mask:0xc
    v_mov_b32_dpp v42, v110 row_ror:8 row_mask:0xf bank_mask:0xc
    v_mov_b32_dpp v43, v111 row_ror:8 row_mask:0xf bank_mask:0xc
    v_mov_b32 v108, v60
    v_mov_b32 v109, v61
    v_mov_b32 v110, v62
    v_mov_b32 v111, v63
    v_mov_b32_dpp v60, v44 row_ror:8 row_mask:0xf bank_mask:0x3
    v_mov_b32_dpp v61, v45 row_ror:8 row_mask:0xf bank_mask:0x3
    v_mov_b32_dpp v62, v46 row_ror:8 row_mask:0xf bank_mask:0x3
    v_mov_b32_dpp v63, v47 row_ror:8 row_mask:0xf bank_mask:0x3
    v_mov_b32_dpp v44, v108 row_ror:8 row_mask:0xf bank_mask:0xc
    v_mov_b32_dpp v45, v109 row_ror:8 row_mask:0xf bank_mask:0xc
    v_mov_b32_dpp v46, v110 row_ror:8 row_mask:0xf bank_mask:0xc
    v_mov_b32_dpp v47, v111 row_ror:8 row_mask:0xf bank_mask:0xc
    v_mov_b32 v108, v64
    v_mov_b32 v109, v65
    v_mov_b32 v110, v66
    v_mov_b32 v111, v67
    v_mov_b32_dpp v64, v48 row_ror:8 row_mask:0xf bank_mask:0x3
    v_mov_b32_dpp v65, v49 row_ror:8 row_mask:0xf bank_mask:0x3
    v_mov_b32_dpp v66, v50 row_ror:8 row_mask:0xf bank_mask:0x3
    v_mov_b32_dpp v67, v51 row_ror:8 row_mask:0xf bank_mask:0x3
    v_mov_b32_dpp v48, v108 row_ror:8 row_mask:0xf bank_mask:0xc
    v_mov_b32_dpp v49, v109 row_ror:8 row_mask:0xf bank_mask:0xc
    v_mov_b32_dpp v50, v110 row_ror:8 row_mask:0xf bank_mask:0xc
    v_mov_b32_dpp v51, v111 row_ror:8 row_mask:0xf bank_mask:0xc
    v_mov_b32 v108, v68
    v_mov_b32 v109, v69
    v_mov_b32 v110, v70
    v_mov_b32 v111, v71
    v_mov_b32_dpp v68, v52 row_ror:8 row_mask:0xf bank_mask:0x3
    v_mov_b32_dpp v69, v53 row_ror:8 row_mask:0xf bank_mask:0x3
    v_mov_b32_dpp v70, v54 row_ror:8 row_mask:0xf bank_mask:0x3
    v_mov_b32_dpp v71, v55 row_ror:8 row_mask:0xf bank_mask:0x3
    v_mov_b32_dpp v52, v108 row_ror:8 row_mask:0xf bank_mask:0xc
    v_mov_b32_dpp v53, v109 row_ror:8 row_mask:0xf bank_mask:0xc
    v_mov_b32_dpp v54, v110 row_ror:8 row_mask:0xf bank_mask:0xc
    v_mov_b32_dpp v55, v111 row_ror:8 row_mask:0xf bank_mask:0xc
    s_barrier
    s_cmp_ge_u32 s3, 8
    s_cbranch_scc1 L_ad_hipost
    s_lshl_b32 s45, s4, 4
    s_add_u32 s45, s45, s5
    s_lshl_b32 s45, s45, 6
    s_add_u32 s45, s45, 0x1f8000
    v_mov_b32 v10, s45
    s_mov_b32 s44, 0
    s_mov_b64 exec, 1
Lhint_4:
    global_load_dword v11, v10, s[34:35] sc1
    s_waitcnt vmcnt(0)
    v_readfirstlane_b32 s45, v11
    s_add_u32 s44, s44, 1
    s_cmp_eq_u32 s45, s43
    s_cbranch_scc1 Lhint_4_d
    s_cmp_lt_u32 s44, 60
    s_cbranch_scc1 Lhint_4
Lhint_4_d:
    s_mov_b64 exec, -1
    s_mov_b32 s44, 0
Lpoll_5:
    global_load_dwordx2 v[8:9], v102, s[34:35] sc1
    s_mov_b64 exec, s[52:53]
    global_load_dwordx4 v[72:75], v101, s[34:35] sc1
    global_load_dwordx4 v[76:79], v101, s[34:35] offset:64 sc1
    s_mov_b64 exec, -1
    s_waitcnt vmcnt(0)
    v_max_u32 v112, v8, v9
    v_max3_u32 v112, v112, v72, v73
    v_max3_u32 v112, v112, v74, v75
    v_max3_u32 v112, v112, v76, v77
    v_max3_u32 v112, v112, v78, v79
    v_cmp_eq_u32 s[50:51], -1, v112
    s_mov_b64 exec, -1
    s_cmp_eq_u64 s[50:51], 0
    s_cbranch_scc1 Lpdone_6
    s_add_u32 s44, s44, 1
    s_cmp_lt_u32 s44, 100000
    s_cbranch_scc1 Lpoll_5
    v_mov_b32 v112, 20
    v_mov_b32 v2, s2
    v_add_u32 v2, 0x10000, v2
    global_store_dword v112, v2, s[32:33]
Lpdone_6:
    v_mov_b32 v10, v8
    v_mfma_f32_16x16x32_bf16 v[80:83], v[72:75], v[40:43], 0
    v_mfma_f32_16x16x32_bf16 v[84:87], v[72:75], v[44:47], 0
    v_mfma_f32_16x16x32_bf16 v[88:91], v[72:75], v[48:51], 0
    v_mfma_f32_16x16x32_bf16 v[92:95], v[72:75], v[52:55], 0
    s_nop 1
    v_max_f32_dpp v10, v10, v10 quad_perm:[1,0,3,2] row_mask:0xf bank_mask:0xf
    s_nop 1
    v_max_f32_dpp v10, v10, v10 quad_perm:[2,3,0,1] row_mask:0xf bank_mask:0xf
    v_mfma_f32_16x16x32_bf16 v[80:83], v[76:79], v[56:59], v[80:83]
    v_mfma_f32_16x16x32_bf16 v[84:87], v[76:79], v[60:63], v[84:87]
    v_mfma_f32_16x16x32_bf16 v[88:91], v[76:79], v[64:67], v[88:91]
    v_mfma_f32_16x16x32_bf16 v[92:95], v[76:79], v[68:71], v[92:95]
    v_mov_b32 v11, v10
    s_nop 1
    v_permlane16_swap_b32 v10, v11
    s_nop 1
    v_max_f32 v10, v10, v11
    v_sub_f32 v8, v8, v10
    v_exp_f32 v8, v8
    s_nop 0
    v_mul_f32 v9, v8, v9
    s_nop 0
    v_mul_f32_dpp v80, v8, v80 row_newbcast:0 row_mask:0xf bank_mask:0xf
    v_mul_f32_dpp v84, v8, v84 row_newbcast:0 row_mask:0xf bank_mask:0xf
    v_mul_f32_dpp v88, v8, v88 row_newbcast:0 row_mask:0xf bank_mask:0xf
    v_mul_f32_dpp v92, v8, v92 row_newbcast:0 row_mask:0xf bank_mask:0xf
    v_add_f32_dpp v9, v9, v9 quad_perm:[1,0,3,2] row_mask:0xf bank_mask:0xf
    v_fmac_f32_dpp v80, v8, v81 row_newbcast:1 row_mask:0xf bank_mask:0xf
    v_fmac_f32_dpp v84, v8, v85 row_newbcast:1 row_mask:0xf bank_mask:0xf
    v_fmac_f32_dpp v88, v8, v89 row_newbcast:1 row_mask:0xf bank_mask:0xf
    v_fmac_f32_dpp v92, v8, v93 row_newbcast:1 row_mask:0xf bank_mask:0xf
    v_add_f32_dpp v9, v9, v9 quad_perm:[2,3,0,1] row_mask:0xf bank_mask:0xf
    v_fmac_f32_dpp v80, v8, v82 row_newbcast:2 row_mask:0xf bank_mask:0xf
    v_fmac_f32_dpp v84, v8, v86 row_newbcast:2 row_mask:0xf bank_mask:0xf
    v_fmac_f32_dpp v88, v8, v90 row_newbcast:2 row_mask:0xf bank_mask:0xf
    v_fmac_f32_dpp v92, v8, v94 row_newbcast:2 row_mask:0xf bank_mask:0xf
    v_mov_b32 v11, v9
    v_fmac_f32_dpp v80, v8, v83 row_newbcast:3 row_mask:0xf bank_mask:0xf
    v_fmac_f32_dpp v84, v8, v87 row_newbcast:3 row_mask:0xf bank_mask:0xf
    v_fmac_f32_dpp v88, v8, v91 row_newbcast:3 row_mask:0xf bank_mask:0xf
    v_fmac_f32_dpp v92, v8, v95 row_newbcast:3 row_mask:0xf bank_mask:0xf
    v_permlane16_swap_b32 v9, v11
    s_nop 0
    v_add_f32 v9, v9, v11
    v_rcp_f32 v9, v9
    s_nop 1
    v_permlane32_swap_b32 v80, v88
    v_permlane32_swap_b32 v84, v92
    s_nop 1
    v_add_f32 v80, v80, v88
    v_add_f32 v84, v84, v92
    s_nop 1
    v_permlane16_swap_b32 v80, v84
    s_nop 1
    v_add_f32 v80, v80, v84
    v_mul_f32 v80, v80, v9
    v_cvt_pk_bf16_f32 v80, v80, v80
    ds_write_b16 v5, v80 offset:8192
    s_waitcnt lgkmcnt(0)
    s_barrier
L_ad_end:
    s_endpgm
L_bc:
    s_sub_u32 s7, s5, 16
    s_lshl_b32 s47, s4, 4
    s_add_u32 s47, s47, s7
    s_add_u32 s55, s3, s7
    s_and_b32 s55, s55, 15
    s_lshl_b32 s45, s47, 17
    s_lshl_b32 s46, s55, 7
    s_add_u32 s45, s45, s46
    v_and_b32 v5, 7, v3
    v_lshlrev_b32 v5, 11, v5
    v_lshrrev_b32 v6, 3, v3
    v_lshl_add_u32 v5, v6, 6, v5
    v_lshl_add_u32 v5, v4, 4, v5
    v_add_u32 v116, s45, v5
    v_mov_b32 v104, 0
    v_mov_b32 v105, 0
    v_mov_b32 v106, 0
    v_mov_b32 v107, 0
    s_mov_b32 s52, 0xffffffff
    s_mov_b32 s53, 0xffffff
    s_waitcnt lgkmcnt(0)
    s_load_dword s43, s[34:35], 0
    s_lshr_b32 s49, s7, 2
    s_lshl_b32 s49, s49, 3
    s_add_u32 s49, s49, s4
    s_lshl_b32 s6, s49, 2
    s_and_b32 s45, s7, 3
    s_add_u32 s6, s6, s45
    s_cmp_lg_u32 s3, 0
    s_cbranch_scc1 L_bc_nox
    s_mov_b64 exec, s[52:53]
    global_load_dwordx4 v[104:107], v118, s[8:9]
    s_min_u32 s45, s6, 111
    s_lshl_b32 s45, s45, 5
    v_lshlrev_b32 v102, 2, v1
    v_add_u32 v101, s45, v102
    s_mov_b64 exec, 0xff
    global_load_dword v103, v101, s[24:25]
    s_mov_b64 exec, -1
L_bc_nox:
    s_cmp_ge_u32 s3, 8
    s_cbranch_scc1 L_bc_noml
    s_cmp_ge_u32 s49, 28
    s_cbranch_scc1 L_nomlp_7
    s_and_b32 s45, s7, 3
    s_mul_i32 s45, s45, 112
    s_lshl_b32 s46, s3, 3
    s_add_u32 s45, s45, s46
    v_lshrrev_b32 v0, 3, v1
    v_add_u32 v0, s45, v0
    v_mul_u32_u24 v0, 3584, v0
    v_and_b32 v2, 7, v1
    v_lshl_add_u32 v0, v2, 4, v0
    s_lshl_b32 s45, s49, 7
    v_add_u32 v0, s45, v0
    s_lshl_b32 s46, s3, 10
    s_add_u32 s46, s46, 0x2000
    s_mov_b32 m0, s46
    v_add_u32 v2, 229376, v0
    global_load_lds_dwordx4 v0, s[22:23] nt
    s_cmp_ge_u32 s3, 6
    s_cbranch_scc1 L_nomlp_7_b
    s_add_u32 s45, s46, 0x2000
    s_mov_b32 m0, s45
    s_nop 0
    global_load_lds_dwordx4 v2, s[22:23] nt
L_nomlp_7_b:
L_nomlp_7:
L_bc_noml:
    s_barrier
    s_cmp_lg_u32 s3, 1
    s_cbranch_scc1 L_bc_nowarm
    s_getpc_b64 s[56:57]
L_pc_981:
    s_sub_u32 s56, s56, L_pc_981-recurrent_scan__compressed_kv_cla__dense_activation_squared_relu__decode_kernel
    s_subb_u32 s57, s57, 0
    s_and_b32 s45, s5, 15
    s_lshl_b32 s45, s45, 10
    v_add_u32 v126, s45, v118
    v_min_u32 v126, L_code_end-recurrent_scan__compressed_kv_cla__dense_activation_squared_relu__decode_kernel-16, v126
    global_load_dwordx4 v[112:115], v126, s[56:57]
L_bc_nowarm:
    global_load_dwordx4 v[8:11], v116, s[10:11]
    v_add_u32 v116, 16384, v116
    global_load_dwordx4 v[12:15], v116, s[10:11]
    v_add_u32 v116, 16384, v116
    global_load_dwordx4 v[16:19], v116, s[10:11]
    v_add_u32 v116, 16384, v116
    global_load_dwordx4 v[20:23], v116, s[10:11]
    v_add_u32 v116, 16384, v116
    global_load_dwordx4 v[24:27], v116, s[10:11]
    v_add_u32 v116, 16384, v116
    global_load_dwordx4 v[28:31], v116, s[10:11]
    v_add_u32 v116, 16384, v116
    global_load_dwordx4 v[32:35], v116, s[10:11]
    v_add_u32 v116, 16384, v116
    global_load_dwordx4 v[36:39], v116, s[10:11]
    s_sub_u32 s48, s7, s3
    s_and_b32 s48, s48, 15
    s_lshl_b32 s45, s4, 4
    s_add_u32 s48, s48, s45
    s_lshl_b32 s45, s48, 17
    s_lshl_b32 s46, s7, 7
    s_add_u32 s45, s45, s46
    v_lshl_add_u32 v7, v6, 2, v4
    v_lshlrev_b32 v7, 14, v7
    v_and_b32 v6, 7, v3
    v_lshl_add_u32 v7, v6, 4, v7
    v_add_u32 v108, s45, v7
    s_lshl_b32 s45, s55, 11
    s_add_u32 s45, s45, 0x2000
    v_lshlrev_b32 v5, 6, v3
    v_lshl_add_u32 v5, v4, 4, v5
    v_add_u32 v5, s45, v5
    s_lshr_b32 s45, s55, 1
    s_lshl_b32 s45, s45, 2
    s_add_u32 s45, s45, 0x1000
    v_lshlrev_b32 v6, 7, v3
    v_add_u32 v6, s45, v6
    s_mul_i32 s45, s3, 4352
    s_add_u32 s45, s45, 0xa000
    v_mul_u32_u24 v116, 272, v3
    v_lshl_add_u32 v116, v4, 4, v116
    v_add_u32 v116, s45, v116
    s_mul_i32 s45, s3, 272
    s_add_u32 s45, s45, 0xa000
    v_lshlrev_b32 v117, 2, v1
    v_add_u32 v117, s45, v117
    v_add_u32 v119, 34816, v117
    v_lshrrev_b32 v124, 3, v1
    v_lshlrev_b32 v124, 4, v124
    s_movk_i32 s45, 128
    v_writelane_b32 v124, s45, 1
    s_mul_i32 s45, s47, 2304
    s_add_u32 s45, s45, 0x51000
    v_lshrrev_b32 v125, 5, v1
    v_lshlrev_b32 v125, 10, v125
    v_bfe_u32 v126, v1, 3, 2
    v_lshl_add_u32 v125, v126, 4, v125
    s_lshl_b32 s46, s3, 6
    s_add_u32 s46, s46, s45
    v_add_u32 v125, s46, v125
    s_lshl_b32 s46, s3, 4
    s_add_u32 s46, s46, s45
    s_add_u32 s46, s46, 2048
    v_writelane_b32 v125, s46, 1
    s_lshl_b32 s45, s3, 4
    s_add_u32 s45, s45, s7
    s_lshl_b32 s45, s45, 3
    s_add_u32 s45, s45, s4
    s_lshl_b32 s46, s45, 7
    s_add_u32 s46, s46, 0x128000
    v_add_u32 v124, s46, v124
    s_lshl_b32 s46, s45, 6
    s_add_u32 s46, s46, 0x168000
    v_writelane_b32 v124, s46, 1
    s_mul_i32 s45, s48, 2304
    s_add_u32 s45, s45, 0x51000
    v_lshlrev_b32 v126, 4, v3
    v_add_u32 v126, s45, v126
    v_lshlrev_b32 v7, 6, v3
    v_lshl_add_u32 v7, v4, 4, v7
    v_add_u32 v7, s45, v7
    s_lshl_b32 s45, s3, 7
    v_lshlrev_b32 v110, 3, v3
    v_add_u32 v110, s45, v110
    s_lshl_b32 s45, s3, 3
    v_lshlrev_b32 v111, 7, v3
    v_add_u32 v111, s45, v111
    s_mul_i32 s55, s4, 14
    s_add_u32 s55, s55, s7
    s_add_u32 s96, s34, 0x8f000
    s_addc_u32 s97, s35, 0
    s_waitcnt lgkmcnt(0)
    s_add_u32 s43, s43, 0x01010101
    s_and_b32 s45, s43, 0xff
    v_mov_b32 v120, s45
    s_bfe_u32 s45, s43, 0x80008
    v_mov_b32 v121, s45
    s_bfe_u32 s45, s43, 0x80010
    v_mov_b32 v122, s45
    s_lshr_b32 s45, s43, 24
    v_mov_b32 v123, s45
    s_waitcnt vmcnt(8)
    s_cmp_lg_u32 s3, 0
    s_cbranch_scc1 L_bc_noln
    v_lshlrev_b32 v72, 16, v104
    v_and_b32 v73, 0xffff0000, v104
    v_lshlrev_b32 v74, 16, v105
    v_and_b32 v75, 0xffff0000, v105
    v_lshlrev_b32 v76, 16, v106
    v_and_b32 v77, 0xffff0000, v106
    v_lshlrev_b32 v78, 16, v107
    v_and_b32 v79, 0xffff0000, v107
    v_add_f32 v80, v72, v73
    v_add_f32 v81, v74, v75
    v_add_f32 v82, v76, v77
    v_add_f32 v83, v78, v79
    v_add_f32 v80, v80, v81
    v_add_f32 v82, v82, v83
    v_add_f32 v80, v80, v82
    s_nop 1
    v_add_f32_dpp v80, v80, v80 row_shr:1 row_mask:0xf bank_mask:0xf bound_ctrl:0
    s_nop 1
    v_add_f32_dpp v80, v80, v80 row_shr:2 row_mask:0xf bank_mask:0xf bound_ctrl:0
    s_nop 1
    v_add_f32_dpp v80, v80, v80 row_shr:4 row_mask:0xf bank_mask:0xf bound_ctrl:0
    s_nop 1
    v_add_f32_dpp v80, v80, v80 row_shr:8 row_mask:0xf bank_mask:0xf bound_ctrl:0
    s_nop 1
    v_add_f32_dpp v80, v80, v80 row_bcast:15 row_mask:0xa bank_mask:0xf
    s_nop 1
    v_add_f32_dpp v80, v80, v80 row_bcast:31 row_mask:0xc bank_mask:0xf
    s_nop 0
    v_readlane_b32 s45, v80, 63
    s_nop 1
    v_mov_b32 v81, 0x3b124925
    v_mul_f32 v84, s45, v81
    v_mov_b32 v80, 0
    v_mov_b32 v82, 0
    s_mov_b64 exec, s[52:53]
    v_sub_f32 v72, v72, v84
    v_sub_f32 v73, v73, v84
    v_sub_f32 v74, v74, v84
    v_sub_f32 v75, v75, v84
    v_sub_f32 v76, v76, v84
    v_sub_f32 v77, v77, v84
    v_sub_f32 v78, v78, v84
    v_sub_f32 v79, v79, v84
    v_fmac_f32 v80, v72, v72
    v_fmac_f32 v82, v73, v73
    v_fmac_f32 v80, v74, v74
    v_fmac_f32 v82, v75, v75
    v_fmac_f32 v80, v76, v76
    v_fmac_f32 v82, v77, v77
    v_fmac_f32 v80, v78, v78
    v_fmac_f32 v82, v79, v79
    v_add_f32 v80, v80, v82
    s_mov_b64 exec, -1
    s_nop 1
    v_add_f32_dpp v80, v80, v80 row_shr:1 row_mask:0xf bank_mask:0xf bound_ctrl:0
    s_nop 1
    v_add_f32_dpp v80, v80, v80 row_shr:2 row_mask:0xf bank_mask:0xf bound_ctrl:0
    s_nop 1
    v_add_f32_dpp v80, v80, v80 row_shr:4 row_mask:0xf bank_mask:0xf bound_ctrl:0
    s_nop 1
    v_add_f32_dpp v80, v80, v80 row_shr:8 row_mask:0xf bank_mask:0xf bound_ctrl:0
    s_nop 1
    v_add_f32_dpp v80, v80, v80 row_bcast:15 row_mask:0xa bank_mask:0xf
    s_nop 1
    v_add_f32_dpp v80, v80, v80 row_bcast:31 row_mask:0xc bank_mask:0xf
    s_nop 0
    v_readlane_b32 s45, v80, 63
    s_nop 1
    v_mul_f32 v85, s45, v81
    v_cvt_pk_bf16_f32 v86, v84, v85
    v_lshlrev_b32 v84, 16, v86
    v_and_b32 v85, 0xffff0000, v86
    v_add_f32 v85, 0x3727c5ac, v85
    v_cvt_pk_bf16_f32 v86, v85, v85
    v_lshlrev_b32 v85, 16, v86
    v_sqrt_f32 v85, v85
    s_nop 0
    v_cvt_pk_bf16_f32 v86, v85, v85
    v_lshlrev_b32 v85, 16, v86
    v_rcp_f32 v86, v85
    v_readfirstlane_b32 s40, v84
    v_readfirstlane_b32 s41, v85
    v_readfirstlane_b32 s42, v86
    s_nop 1
    v_lshlrev_b32 v72, 16, v104
    v_and_b32 v73, 0xffff0000, v104
    v_lshlrev_b32 v74, 16, v105
    v_and_b32 v75, 0xffff0000, v105
    v_lshlrev_b32 v76, 16, v106
    v_and_b32 v77, 0xffff0000, v106
    v_lshlrev_b32 v78, 16, v107
    v_and_b32 v79, 0xffff0000, v107
    v_subrev_f32 v72, s40, v72
    v_subrev_f32 v73, s40, v73
    v_subrev_f32 v74, s40, v74
    v_subrev_f32 v75, s40, v75
    v_subrev_f32 v76, s40, v76
    v_subrev_f32 v77, s40, v77
    v_subrev_f32 v78, s40, v78
    v_subrev_f32 v79, s40, v79
    v_cvt_pk_bf16_f32 v80, v72, v73
    v_lshlrev_b32 v72, 16, v80
    v_and_b32 v73, 0xffff0000, v80
    v_cvt_pk_bf16_f32 v80, v74, v75
    v_lshlrev_b32 v74, 16, v80
    v_and_b32 v75, 0xffff0000, v80
    v_cvt_pk_bf16_f32 v80, v76, v77
    v_lshlrev_b32 v76, 16, v80
    v_and_b32 v77, 0xffff0000, v80
    v_cvt_pk_bf16_f32 v80, v78, v79
    v_lshlrev_b32 v78, 16, v80
    v_and_b32 v79, 0xffff0000, v80
    v_mul_f32 v80, s42, v72
    v_fma_f32 v81, -v80, s41, v72
    v_fma_f32 v72, v81, s42, v80
    v_mul_f32 v80, s42, v73
    v_fma_f32 v81, -v80, s41, v73
    v_fma_f32 v73, v81, s42, v80
    v_mul_f32 v80, s42, v74
    v_fma_f32 v81, -v80, s41, v74
    v_fma_f32 v74, v81, s42, v80
    v_mul_f32 v80, s42, v75
    v_fma_f32 v81, -v80, s41, v75
    v_fma_f32 v75, v81, s42, v80
    v_mul_f32 v80, s42, v76
    v_fma_f32 v81, -v80, s41, v76
    v_fma_f32 v76, v81, s42, v80
    v_mul_f32 v80, s42, v77
    v_fma_f32 v81, -v80, s41, v77
    v_fma_f32 v77, v81, s42, v80
    v_mul_f32 v80, s42, v78
    v_fma_f32 v81, -v80, s41, v78
    v_fma_f32 v78, v81, s42, v80
    v_mul_f32 v80, s42, v79
    v_fma_f32 v81, -v80, s41, v79
    v_fma_f32 v79, v81, s42, v80
    v_cvt_pk_bf16_f32 v80, v72, v73
    v_lshlrev_b32 v72, 16, v80
    v_and_b32 v73, 0xffff0000, v80
    v_cvt_pk_bf16_f32 v80, v74, v75
    v_lshlrev_b32 v74, 16, v80
    v_and_b32 v75, 0xffff0000, v80
    v_cvt_pk_bf16_f32 v80, v76, v77
    v_lshlrev_b32 v76, 16, v80
    v_and_b32 v77, 0xffff0000, v80
    v_cvt_pk_bf16_f32 v80, v78, v79
    v_lshlrev_b32 v78, 16, v80
    v_and_b32 v79, 0xffff0000, v80
    v_lshlrev_b32 v80, 5, v1
    ds_write_b128 v80, v[72:75] offset:2048
    ds_write_b128 v80, v[76:79] offset:2064
    s_mov_b64 exec, 0xff
    ds_write_b32 v102, v103 offset:7680
    s_mov_b64 exec, -1
L_bc_noln:
    s_waitcnt lgkmcnt(0)
    s_barrier
    s_cmp_ge_u32 s49, 28
    s_cbranch_scc1 L_mlp_8_done
    s_cmp_ge_u32 s3, 14
    s_cbranch_scc1 L_mlp_8_bar
    s_and_b32 s45, s7, 3
    s_mul_i32 s45, s45, 448
    s_lshl_b32 s46, s3, 5
    s_add_u32 s45, s45, s46
    v_lshrrev_b32 v100, 3, v1
    v_lshlrev_b32 v100, 2, v100
    v_add_u32 v100, s45, v100
    ds_read_b32 v96, v100 offset:2048
    s_lshl_b32 s45, s3, 10
    v_add_u32 v99, s45, v118
    ds_read_b128 v[88:91], v99 offset:8192
    v_and_b32 v98, 1, v4
    v_lshrrev_b32 v97, 1, v4
    v_lshl_add_u32 v98, v97, 2, v98
    v_and_b32 v97, 7, v1
    v_lshl_add_u32 v98, v97, 3, v98
    v_lshlrev_b32 v98, 2, v98
    s_lshl_b32 s45, s3, 8
    v_add_u32 v98, s45, v98
    s_waitcnt lgkmcnt(0)
    v_lshlrev_b32 v72, 16, v88
    v_and_b32 v73, 0xffff0000, v88
    v_lshlrev_b32 v74, 16, v89
    v_and_b32 v75, 0xffff0000, v89
    v_lshlrev_b32 v76, 16, v90
    v_and_b32 v77, 0xffff0000, v90
    v_lshlrev_b32 v78, 16, v91
    v_and_b32 v79, 0xffff0000, v91
    v_mul_f32 v72, v96, v72
    v_mul_f32 v73, v96, v73
    v_mul_f32 v74, v96, v74
    v_mul_f32 v75, v96, v75
    v_mul_f32 v76, v96, v76
    v_mul_f32 v77, v96, v77
    v_mul_f32 v78, v96, v78
    v_mul_f32 v79, v96, v79
    s_nop 1
    v_permlane32_swap_b32 v72, v76
    v_permlane32_swap_b32 v73, v77
    v_permlane32_swap_b32 v74, v78
    v_permlane32_swap_b32 v75, v79
    s_nop 1
    v_add_f32 v72, v72, v76
    v_add_f32 v73, v73, v77
    v_add_f32 v74, v74, v78
    v_add_f32 v75, v75, v79
    s_nop 1
    v_permlane16_swap_b32 v72, v73
    v_permlane16_swap_b32 v74, v75
    s_nop 1
    v_add_f32 v72, v72, v73
    v_add_f32 v74, v74, v75
    s_nop 1
    v_add_f32_dpp v72, v72, v72 row_ror:8 row_mask:0xf bank_mask:0xf
    v_add_f32_dpp v74, v74, v74 row_ror:8 row_mask:0xf bank_mask:0xf
    ds_write_b32 v98, v72 offset:4096
    ds_write_b32 v98, v74 offset:4104
L_mlp_8_bar:
    s_waitcnt lgkmcnt(0)
    s_barrier
    s_cmp_lg_u32 s3, 15
    s_cbranch_scc1 L_mlp_8_done
    v_lshlrev_b32 v98, 2, v1
    ds_read_b32 v72, v98 offset:4096
    ds_read_b32 v73, v98 offset:4352
    ds_read_b32 v74, v98 offset:4608
    ds_read_b32 v75, v98 offset:4864
    ds_read_b32 v76, v98 offset:5120
    ds_read_b32 v77, v98 offset:5376
    ds_read_b32 v78, v98 offset:5632
    ds_read_b32 v79, v98 offset:5888
    ds_read_b32 v80, v98 offset:6144
    ds_read_b32 v81, v98 offset:6400
    ds_read_b32 v82, v98 offset:6656
    ds_read_b32 v83, v98 offset:6912
    ds_read_b32 v84, v98 offset:7168
    ds_read_b32 v85, v98 offset:7424
    s_lshl_b32 s45, s6, 8
    s_add_u32 s45, s45, 0xa000
    v_add_u32 v98, s45, v98
    v_and_b32 v97, 3, v1
    v_lshlrev_b32 v97, 3, v97
    v_lshrrev_b32 v97, v97, s43
    s_waitcnt lgkmcnt(0)
    v_add_f32 v72, v72, v79
    v_add_f32 v73, v73, v80
    v_add_f32 v74, v74, v81
    v_add_f32 v75, v75, v82
    v_add_f32 v76, v76, v83
    v_add_f32 v77, v77, v84
    v_add_f32 v78, v78, v85
    v_add_f32 v72, v72, v75
    v_add_f32 v73, v73, v76
    v_add_f32 v74, v74, v77
    v_add_f32 v72, v72, v73
    v_add_f32 v74, v74, v78
    v_add_f32 v72, v72, v74
    v_bfi_b32 v72, s38, v97, v72
    s_nop 1
    v_mov_b32_dpp v73, v72 row_shl:1 row_mask:0xf bank_mask:0xf
    v_mov_b32_dpp v74, v72 row_shl:2 row_mask:0xf bank_mask:0xf
    v_mov_b32_dpp v75, v72 row_shl:3 row_mask:0xf bank_mask:0xf
    s_mov_b32 s58, 0x11111111
    s_mov_b32 s59, 0x11111111
    s_mov_b64 exec, s[58:59]
    global_store_dwordx4 v98, v[72:75], s[34:35]
    global_store_dwordx4 v98, v[72:75], s[96:97] sc1
    s_mov_b64 exec, -1
L_mlp_8_done:
    s_mov_b32 s52, 0x1010103
    s_mov_b32 s53, 0x1010101
    s_waitcnt vmcnt(0)
    s_mov_b32 s54, s3
    global_load_dwordx4 v[40:43], v108, s[10:11] offset:0
    global_load_dwordx4 v[44:47], v108, s[10:11] offset:2048
    v_add_u32 v108, 4096, v108
    global_load_dwordx4 v[48:51], v108, s[10:11] offset:0
    global_load_dwordx4 v[52:55], v108, s[10:11] offset:2048
    v_add_u32 v108, 4096, v108
    global_load_dwordx4 v[56:59], v108, s[10:11] offset:0
    global_load_dwordx4 v[60:63], v108, s[10:11] offset:2048
    v_add_u32 v108, 4096, v108
    global_load_dwordx4 v[64:67], v108, s[10:11] offset:0
    global_load_dwordx4 v[68:71], v108, s[10:11] offset:2048
    v_mov_b32 v112, v12
    v_mov_b32 v113, v13
    v_mov_b32 v114, v14
    v_mov_b32 v115, v15
    v_mov_b32_dpp v12, v8 row_ror:8 row_mask:0xf bank_mask:0x3
    v_mov_b32_dpp v13, v9 row_ror:8 row_mask:0xf bank_mask:0x3
    v_mov_b32_dpp v14, v10 row_ror:8 row_mask:0xf bank_mask:0x3
    v_mov_b32_dpp v15, v11 row_ror:8 row_mask:0xf bank_mask:0x3
    v_mov_b32_dpp v8, v112 row_ror:8 row_mask:0xf bank_mask:0xc
    v_mov_b32_dpp v9, v113 row_ror:8 row_mask:0xf bank_mask:0xc
    v_mov_b32_dpp v10, v114 row_ror:8 row_mask:0xf bank_mask:0xc
    v_mov_b32_dpp v11, v115 row_ror:8 row_mask:0xf bank_mask:0xc
    v_mov_b32 v112, v20
    v_mov_b32 v113, v21
    v_mov_b32 v114, v22
    v_mov_b32 v115, v23
    v_mov_b32_dpp v20, v16 row_ror:8 row_mask:0xf bank_mask:0x3
    v_mov_b32_dpp v21, v17 row_ror:8 row_mask:0xf bank_mask:0x3
    v_mov_b32_dpp v22, v18 row_ror:8 row_mask:0xf bank_mask:0x3
    v_mov_b32_dpp v23, v19 row_ror:8 row_mask:0xf bank_mask:0x3
    v_mov_b32_dpp v16, v112 row_ror:8 row_mask:0xf bank_mask:0xc
    v_mov_b32_dpp v17, v113 row_ror:8 row_mask:0xf bank_mask:0xc
    v_mov_b32_dpp v18, v114 row_ror:8 row_mask:0xf bank_mask:0xc
    v_mov_b32_dpp v19, v115 row_ror:8 row_mask:0xf bank_mask:0xc
    v_mov_b32 v112, v28
    v_mov_b32 v113, v29
    v_mov_b32 v114, v30
    v_mov_b32 v115, v31
    v_mov_b32_dpp v28, v24 row_ror:8 row_mask:0xf bank_mask:0x3
    v_mov_b32_dpp v29, v25 row_ror:8 row_mask:0xf bank_mask:0x3
    v_mov_b32_dpp v30, v26 row_ror:8 row_mask:0xf bank_mask:0x3
    v_mov_b32_dpp v31, v27 row_ror:8 row_mask:0xf bank_mask:0x3
    v_mov_b32_dpp v24, v112 row_ror:8 row_mask:0xf bank_mask:0xc
    v_mov_b32_dpp v25, v113 row_ror:8 row_mask:0xf bank_mask:0xc
    v_mov_b32_dpp v26, v114 row_ror:8 row_mask:0xf bank_mask:0xc
    v_mov_b32_dpp v27, v115 row_ror:8 row_mask:0xf bank_mask:0xc
    v_mov_b32 v112, v36
    v_mov_b32 v113, v37
    v_mov_b32 v114, v38
    v_mov_b32 v115, v39
    v_mov_b32_dpp v36, v32 row_ror:8 row_mask:0xf bank_mask:0x3
    v_mov_b32_dpp v37, v33 row_ror:8 row_mask:0xf bank_mask:0x3
    v_mov_b32_dpp v38, v34 row_ror:8 row_mask:0xf bank_mask:0x3
    v_mov_b32_dpp v39, v35 row_ror:8 row_mask:0xf bank_mask:0x3
    v_mov_b32_dpp v32, v112 row_ror:8 row_mask:0xf bank_mask:0xc
    v_mov_b32_dpp v33, v113 row_ror:8 row_mask:0xf bank_mask:0xc
    v_mov_b32_dpp v34, v114 row_ror:8 row_mask:0xf bank_mask:0xc
    v_mov_b32_dpp v35, v115 row_ror:8 row_mask:0xf bank_mask:0xc
    s_waitcnt vmcnt(0)
    v_perm_b32 v72, v44, v40, s36
    v_perm_b32 v73, v52, v48, s36
    v_perm_b32 v74, v60, v56, s36
    v_perm_b32 v75, v68, v64, s36
    v_perm_b32 v76, v44, v40, s37
    v_perm_b32 v77, v52, v48, s37
    v_perm_b32 v78, v60, v56, s37
    v_perm_b32 v79, v68, v64, s37
    v_perm_b32 v80, v45, v41, s36
    v_perm_b32 v81, v53, v49, s36
    v_perm_b32 v82, v61, v57, s36
    v_perm_b32 v83, v69, v65, s36
    v_perm_b32 v84, v45, v41, s37
    v_perm_b32 v85, v53, v49, s37
    v_perm_b32 v86, v61, v57, s37
    v_perm_b32 v87, v69, v65, s37
    v_perm_b32 v88, v46, v42, s36
    v_perm_b32 v89, v54, v50, s36
    v_perm_b32 v90, v62, v58, s36
    v_perm_b32 v91, v70, v66, s36
    v_perm_b32 v92, v46, v42, s37
    v_perm_b32 v93, v54, v50, s37
    v_perm_b32 v94, v62, v58, s37
    v_perm_b32 v95, v70, v66, s37
    v_perm_b32 v96, v47, v43, s36
    v_perm_b32 v97, v55, v51, s36
    v_perm_b32 v98, v63, v59, s36
    v_perm_b32 v99, v71, v67, s36
    v_perm_b32 v100, v47, v43, s37
    v_perm_b32 v101, v55, v51, s37
    v_perm_b32 v102, v63, v59, s37
    v_perm_b32 v103, v71, v67, s37
    v_mov_b32 v112, v88
    v_mov_b32 v113, v89
    v_mov_b32 v114, v90
    v_mov_b32 v115, v91
    v_mov_b32_dpp v88, v72 row_ror:8 row_mask:0xf bank_mask:0x3
    v_mov_b32_dpp v89, v73 row_ror:8 row_mask:0xf bank_mask:0x3
    v_mov_b32_dpp v90, v74 row_ror:8 row_mask:0xf bank_mask:0x3
    v_mov_b32_dpp v91, v75 row_ror:8 row_mask:0xf bank_mask:0x3
    v_mov_b32_dpp v72, v112 row_ror:8 row_mask:0xf bank_mask:0xc
    v_mov_b32_dpp v73, v113 row_ror:8 row_mask:0xf bank_mask:0xc
    v_mov_b32_dpp v74, v114 row_ror:8 row_mask:0xf bank_mask:0xc
    v_mov_b32_dpp v75, v115 row_ror:8 row_mask:0xf bank_mask:0xc
    v_mov_b32 v112, v92
    v_mov_b32 v113, v93
    v_mov_b32 v114, v94
    v_mov_b32 v115, v95
    v_mov_b32_dpp v92, v76 row_ror:8 row_mask:0xf bank_mask:0x3
    v_mov_b32_dpp v93, v77 row_ror:8 row_mask:0xf bank_mask:0x3
    v_mov_b32_dpp v94, v78 row_ror:8 row_mask:0xf bank_mask:0x3
    v_mov_b32_dpp v95, v79 row_ror:8 row_mask:0xf bank_mask:0x3
    v_mov_b32_dpp v76, v112 row_ror:8 row_mask:0xf bank_mask:0xc
    v_mov_b32_dpp v77, v113 row_ror:8 row_mask:0xf bank_mask:0xc
    v_mov_b32_dpp v78, v114 row_ror:8 row_mask:0xf bank_mask:0xc
    v_mov_b32_dpp v79, v115 row_ror:8 row_mask:0xf bank_mask:0xc
    v_mov_b32 v112, v96
    v_mov_b32 v113, v97
    v_mov_b32 v114, v98
    v_mov_b32 v115, v99
    v_mov_b32_dpp v96, v80 row_ror:8 row_mask:0xf bank_mask:0x3
    v_mov_b32_dpp v97, v81 row_ror:8 row_mask:0xf bank_mask:0x3
    v_mov_b32_dpp v98, v82 row_ror:8 row_mask:0xf bank_mask:0x3
    v_mov_b32_dpp v99, v83 row_ror:8 row_mask:0xf bank_mask:0x3
    v_mov_b32_dpp v80, v112 row_ror:8 row_mask:0xf bank_mask:0xc
    v_mov_b32_dpp v81, v113 row_ror:8 row_mask:0xf bank_mask:0xc
    v_mov_b32_dpp v82, v114 row_ror:8 row_mask:0xf bank_mask:0xc
    v_mov_b32_dpp v83, v115 row_ror:8 row_mask:0xf bank_mask:0xc
    v_mov_b32 v112, v100
    v_mov_b32 v113, v101
    v_mov_b32 v114, v102
    v_mov_b32 v115, v103
    v_mov_b32_dpp v100, v84 row_ror:8 row_mask:0xf bank_mask:0x3
    v_mov_b32_dpp v101, v85 row_ror:8 row_mask:0xf bank_mask:0x3
    v_mov_b32_dpp v102, v86 row_ror:8 row_mask:0xf bank_mask:0x3
    v_mov_b32_dpp v103, v87 row_ror:8 row_mask:0xf bank_mask:0x3
    v_mov_b32_dpp v84, v112 row_ror:8 row_mask:0xf bank_mask:0xc
    v_mov_b32_dpp v85, v113 row_ror:8 row_mask:0xf bank_mask:0xc
    v_mov_b32_dpp v86, v114 row_ror:8 row_mask:0xf bank_mask:0xc
    v_mov_b32_dpp v87, v115 row_ror:8 row_mask:0xf bank_mask:0xc
    s_barrier
    s_mov_b64 exec, 0xffff
    global_load_dword v109, v6, s[34:35] sc1
    s_waitcnt vmcnt(0)
    v_cmp_ne_u32 s[50:51], s43, v109
    s_mov_b64 exec, -1
    s_cmp_eq_u64 s[50:51], 0
    s_cbranch_scc1 L_bc_fok
    s_mov_b32 s44, 0
Lpoll_9:
    s_mov_b64 exec, 0xffff
    global_load_dword v109, v6, s[34:35] sc1
    s_waitcnt vmcnt(0)
    v_cmp_ne_u32 vcc, s43, v109
    s_nop 1
    v_cndmask_b32 v112, 0, -1, vcc
    v_cmp_eq_u32 s[50:51], -1, v112
    s_mov_b64 exec, -1
    s_cmp_eq_u64 s[50:51], 0
    s_cbranch_scc1 Lpdone_10
    s_add_u32 s44, s44, 1
    s_cmp_lt_u32 s44, 100000
    s_cbranch_scc1 Lpoll_9
    v_mov_b32 v112, 8
    v_mov_b32 v2, s2
    v_add_u32 v2, 0x10000, v2
    global_store_dword v112, v2, s[32:33]
Lpdone_10:
L_bc_fok:
    global_load_dwordx4 v[104:107], v5, s[34:35] sc1
    global_load_dwordx4 v[112:115], v5, s[34:35] offset:1024 sc1
    s_mov_b32 s44, 0
    s_waitcnt vmcnt(0)
    s_branch Lpchk_12
Lpoll_11:
    global_load_dwordx4 v[104:107], v5, s[34:35] sc1
    global_load_dwordx4 v[112:115], v5, s[34:35] offset:1024 sc1
    s_waitcnt vmcnt(0)
Lpchk_12:
    v_max_u32 v109, v104, v105
    v_max3_u32 v109, v109, v106, v107
    v_max3_u32 v109, v109, v112, v113
    v_max3_u32 v109, v109, v114, v115
    v_cmp_eq_u32 s[50:51], -1, v109
    s_add_u32 s44, s44, 1
    s_cmp_eq_u64 s[50:51], 0
    s_cbranch_scc1 Lpdone_13
    s_cmp_lt_u32 s44, 100000
    s_cbranch_scc1 Lpoll_11
    v_mov_b32 v109, 12
    v_mov_b32 v2, s2
    v_add_u32 v2, 0x10000, v2
    global_store_dword v109, v2, s[32:33]
Lpdone_13:
    v_mfma_f32_16x16x32_bf16 v[40:43], v[8:11], v[104:107], 0
    v_mfma_f32_16x16x32_bf16 v[44:47], v[16:19], v[104:107], 0
    v_mfma_f32_16x16x32_bf16 v[48:51], v[24:27], v[104:107], 0
    v_mfma_f32_16x16x32_bf16 v[52:55], v[32:35], v[104:107], 0
    v_mfma_f32_16x16x32_bf16 v[40:43], v[12:15], v[112:115], v[40:43]
    v_mfma_f32_16x16x32_bf16 v[44:47], v[20:23], v[112:115], v[44:47]
    v_mfma_f32_16x16x32_bf16 v[48:51], v[28:31], v[112:115], v[48:51]
    v_mfma_f32_16x16x32_bf16 v[52:55], v[36:39], v[112:115], v[52:55]
    s_nop 4
    ds_write_b128 v116, v[40:43] offset:0
    ds_write_b128 v116, v[44:47] offset:64
    ds_write_b128 v116, v[48:51] offset:128
    ds_write_b128 v116, v[52:55] offset:192
L_bc_b3:
    s_waitcnt lgkmcnt(0)
    s_barrier
    s_cmp_ge_u32 s3, 8
    s_cbranch_scc1 L_bc_now2
    s_cmp_ge_u32 s49, 28
    s_cbranch_scc1 L_mw2_14
    s_lshl_b32 s45, s6, 4
    v_lshrrev_b32 v0, 3, v1
    v_add_u32 v0, s45, v0
    v_mul_u32_u24 v0, 896, v0
    v_and_b32 v2, 7, v1
    v_min_u32 v2, 6, v2
    v_lshl_add_u32 v0, v2, 4, v0
    s_mul_i32 s45, s3, 112
    v_add_u32 v0, s45, v0
    v_add_u32 v2, 7168, v0
    global_load_dwordx4 v[32:35], v0, s[26:27]
    global_load_dwordx4 v[36:39], v2, s[26:27]
L_mw2_14:
L_bc_now2:
    ds_read_b32 v8, v117 offset:0
    ds_read_b32 v9, v117 offset:4352
    ds_read_b32 v10, v117 offset:8704
    ds_read_b32 v11, v117 offset:13056
    ds_read_b32 v12, v117 offset:17408
    ds_read_b32 v13, v117 offset:21760
    ds_read_b32 v14, v117 offset:26112
    ds_read_b32 v15, v117 offset:30464
    ds_read_b32 v16, v119 offset:0
    ds_read_b32 v17, v119 offset:4352
    ds_read_b32 v18, v119 offset:8704
    ds_read_b32 v19, v119 offset:13056
    ds_read_b32 v20, v119 offset:17408
    ds_read_b32 v21, v119 offset:21760
    ds_read_b32 v22, v119 offset:26112
    ds_read_b32 v23, v119 offset:30464
    s_waitcnt lgkmcnt(8)
    v_add_f32 v8, v8, v12
    v_add_f32 v9, v9, v13
    v_add_f32 v10, v10, v14
    v_add_f32 v11, v11, v15
    v_add_f32 v8, v8, v10
    v_add_f32 v9, v9, v11
    v_add_f32 v8, v8, v9
    s_waitcnt lgkmcnt(0)
    v_add_f32 v16, v16, v20
    v_add_f32 v17, v17, v21
    v_add_f32 v18, v18, v22
    v_add_f32 v19, v19, v23
    v_add_f32 v16, v16, v18
    v_add_f32 v17, v17, v19
    v_add_f32 v16, v16, v17
    v_add_f32 v8, v8, v16
    v_mul_f32 v8, 0x3db8aa3b, v8
    v_mov_b32 v12, v8
    s_nop 1
    v_max_f32_dpp v12, v12, v12 row_ror:8 row_mask:0xf bank_mask:0xf
    s_nop 1
    v_max_f32_dpp v12, v12, v12 row_ror:4 row_mask:0xf bank_mask:0xf
    s_nop 1
    v_max_f32_dpp v12, v12, v12 row_ror:2 row_mask:0xf bank_mask:0xf
    s_nop 1
    v_max_f32_dpp v12, v12, v12 row_ror:1 row_mask:0xf bank_mask:0xf
    v_mov_b32 v10, v12
    s_nop 1
    v_permlane16_swap_b32 v12, v10
    s_nop 1
    v_max_f32 v12, v12, v10
    v_mov_b32 v10, v12
    s_nop 1
    v_permlane32_swap_b32 v12, v10
    s_nop 1
    v_max_f32 v12, v12, v10
    v_sub_f32 v8, v8, v12
    v_exp_f32 v8, v8
    s_nop 1
    v_mov_b32_dpp v10, v8 quad_perm:[1,1,3,3] row_mask:0xf bank_mask:0xf
    v_add_f32_dpp v13, v8, v8 row_ror:8 row_mask:0xf bank_mask:0xf
    v_cvt_pk_bf16_f32 v16, v8, v10
    v_min_u32 v16, 0xfffffffe, v16
    v_add_f32_dpp v13, v13, v13 row_ror:4 row_mask:0xf bank_mask:0xf
    v_min_u32 v12, 0xfffffffe, v12
    v_mov_b32_dpp v17, v16 row_shl:2 row_mask:0xf bank_mask:0xf
    v_add_f32_dpp v13, v13, v13 row_ror:2 row_mask:0xf bank_mask:0xf
    v_mov_b32_dpp v18, v16 row_shl:4 row_mask:0xf bank_mask:0xf
    v_mov_b32_dpp v19, v16 row_shl:6 row_mask:0xf bank_mask:0xf
    v_add_f32_dpp v13, v13, v13 row_ror:1 row_mask:0xf bank_mask:0xf
    v_mov_b32 v11, v13
    s_nop 1
    v_permlane16_swap_b32 v13, v11
    s_nop 1
    v_add_f32 v13, v13, v11
    v_mov_b32 v11, v13
    s_nop 1
    v_permlane32_swap_b32 v13, v11
    s_nop 1
    v_add_f32 v13, v13, v11
    s_mov_b64 exec, 2
    v_mov_b32 v16, v12
    v_min_u32 v17, 0xfffffffe, v13
    s_mov_b64 exec, s[52:53]
    global_store_dwordx4 v125, v[16:19], s[34:35]
    s_mov_b64 exec, -1
    v_mov_b32 v104, v16
    v_mov_b32 v105, v17
    v_mov_b32 v106, v18
    v_mov_b32 v107, v19
    s_mov_b32 s39, 0
    s_barrier
    s_mov_b32 s44, 0
Lpoll_15:
    s_and_b32 s45, s44, 15
    s_cmp_eq_u32 s45, 15
    s_cselect_b64 s[98:99], s[96:97], s[34:35]
    s_cmp_lg_u32 s44, 8
    s_cbranch_scc1 L_s3_18
    s_mov_b64 exec, s[52:53]
    global_store_dwordx4 v125, v[104:107], s[96:97] sc1
    s_mov_b64 exec, -1
    s_mov_b32 s39, 1
L_s3_18:
    global_load_dwordx2 v[48:49], v126, s[98:99] offset:2048 sc1
    global_load_dwordx4 v[40:43], v7, s[98:99] sc1
    global_load_dwordx4 v[44:47], v7, s[98:99] offset:1024 sc1
    s_waitcnt vmcnt(0)
Lpchk_16:
    v_max_u32 v112, v40, v41
    v_max3_u32 v112, v112, v42, v43
    v_max3_u32 v112, v112, v44, v45
    v_max3_u32 v112, v112, v46, v47
    v_max3_u32 v112, v112, v48, v49
    v_cmp_eq_u32 s[50:51], -1, v112
    s_add_u32 s44, s44, 1
    s_cmp_eq_u64 s[50:51], 0
    s_cbranch_scc1 Lpdone_17
    s_cmp_lt_u32 s44, 100000
    s_cbranch_scc1 Lpoll_15
    v_mov_b32 v112, 32
    v_mov_b32 v2, s2
    v_add_u32 v2, 0x10000, v2
    global_store_dword v112, v2, s[32:33]
Lpdone_17:
    v_mfma_f32_16x16x32_bf16 v[52:55], v[72:75], v[40:43], 0
    v_mfma_f32_16x16x32_bf16 v[56:59], v[76:79], v[40:43], 0
    v_mfma_f32_16x16x32_bf16 v[60:63], v[80:83], v[40:43], 0
    v_mfma_f32_16x16x32_bf16 v[64:67], v[84:87], v[40:43], 0
    v_mfma_f32_16x16x32_bf16 v[52:55], v[88:91], v[44:47], v[52:55]
    v_mfma_f32_16x16x32_bf16 v[56:59], v[92:95], v[44:47], v[56:59]
    v_mfma_f32_16x16x32_bf16 v[60:63], v[96:99], v[44:47], v[60:63]
    v_mfma_f32_16x16x32_bf16 v[64:67], v[100:103], v[44:47], v[64:67]
    ds_write_b64 v110, v[48:49] offset:0
    s_nop 3
    ds_write_b128 v116, v[52:55] offset:0
    ds_write_b128 v116, v[56:59] offset:64
    ds_write_b128 v116, v[60:63] offset:128
    ds_write_b128 v116, v[64:67] offset:192
    s_cmp_lg_u32 s39, 0
    s_cbranch_scc1 L_bc_s3d
    s_mov_b64 exec, s[52:53]
    global_store_dwordx4 v125, v[104:107], s[96:97] sc1
    s_mov_b64 exec, -1
L_bc_s3d:
    s_waitcnt lgkmcnt(0)
    s_barrier
    ds_read_b64 v[24:25], v111 offset:0
    ds_read_b32 v8, v117 offset:0
    ds_read_b32 v9, v117 offset:4352
    ds_read_b32 v10, v117 offset:8704
    ds_read_b32 v11, v117 offset:13056
    ds_read_b32 v12, v117 offset:17408
    ds_read_b32 v13, v117 offset:21760
    ds_read_b32 v14, v117 offset:26112
    ds_read_b32 v15, v117 offset:30464
    s_waitcnt lgkmcnt(8)
    v_mov_b32 v26, v24
    ds_read_b32 v16, v119 offset:0
    ds_read_b32 v17, v119 offset:4352
    ds_read_b32 v18, v119 offset:8704
    ds_read_b32 v19, v119 offset:13056
    ds_read_b32 v20, v119 offset:17408
    ds_read_b32 v21, v119 offset:21760
    ds_read_b32 v22, v119 offset:26112
    ds_read_b32 v23, v119 offset:30464
    s_nop 1
    v_max_f32_dpp v26, v26, v26 row_ror:8 row_mask:0xf bank_mask:0xf
    s_nop 1
    v_max_f32_dpp v26, v26, v26 row_ror:4 row_mask:0xf bank_mask:0xf
    s_nop 1
    v_max_f32_dpp v26, v26, v26 row_ror:2 row_mask:0xf bank_mask:0xf
    s_nop 1
    v_max_f32_dpp v26, v26, v26 row_ror:1 row_mask:0xf bank_mask:0xf
    v_sub_f32 v24, v24, v26
    v_exp_f32 v24, v24
    s_waitcnt lgkmcnt(8)
    v_mul_f32 v27, v24, v25
    v_mul_f32_dpp v28, v24, v8 row_newbcast:0 row_mask:0xf bank_mask:0xf
    v_mul_f32_dpp v29, v24, v9 row_newbcast:1 row_mask:0xf bank_mask:0xf
    v_fmac_f32_dpp v28, v24, v10 row_newbcast:2 row_mask:0xf bank_mask:0xf
    v_add_f32_dpp v27, v27, v27 row_ror:8 row_mask:0xf bank_mask:0xf
    v_fmac_f32_dpp v29, v24, v11 row_newbcast:3 row_mask:0xf bank_mask:0xf
    v_fmac_f32_dpp v28, v24, v12 row_newbcast:4 row_mask:0xf bank_mask:0xf
    v_fmac_f32_dpp v29, v24, v13 row_newbcast:5 row_mask:0xf bank_mask:0xf
    v_add_f32_dpp v27, v27, v27 row_ror:4 row_mask:0xf bank_mask:0xf
    v_fmac_f32_dpp v28, v24, v14 row_newbcast:6 row_mask:0xf bank_mask:0xf
    v_fmac_f32_dpp v29, v24, v15 row_newbcast:7 row_mask:0xf bank_mask:0xf
    s_waitcnt lgkmcnt(0)
    v_fmac_f32_dpp v28, v24, v16 row_newbcast:8 row_mask:0xf bank_mask:0xf
    v_add_f32_dpp v27, v27, v27 row_ror:2 row_mask:0xf bank_mask:0xf
    v_fmac_f32_dpp v29, v24, v17 row_newbcast:9 row_mask:0xf bank_mask:0xf
    v_fmac_f32_dpp v28, v24, v18 row_newbcast:10 row_mask:0xf bank_mask:0xf
    v_fmac_f32_dpp v29, v24, v19 row_newbcast:11 row_mask:0xf bank_mask:0xf
    v_add_f32_dpp v27, v27, v27 row_ror:1 row_mask:0xf bank_mask:0xf
    v_fmac_f32_dpp v28, v24, v20 row_newbcast:12 row_mask:0xf bank_mask:0xf
    v_fmac_f32_dpp v29, v24, v21 row_newbcast:13 row_mask:0xf bank_mask:0xf
    v_fmac_f32_dpp v28, v24, v22 row_newbcast:14 row_mask:0xf bank_mask:0xf
    v_fmac_f32_dpp v29, v24, v23 row_newbcast:15 row_mask:0xf bank_mask:0xf
    v_add_f32 v28, v28, v29
    s_nop 1
    v_mov_b32_dpp v29, v28 quad_perm:[1,1,3,3] row_mask:0xf bank_mask:0xf
    v_cvt_pk_bf16_f32 v28, v28, v29
    v_min_u32 v28, 0xfffffffe, v28
    s_nop 1
    v_mov_b32_dpp v29, v28 row_shl:2 row_mask:0xf bank_mask:0xf
    v_mov_b32_dpp v30, v28 row_shl:4 row_mask:0xf bank_mask:0xf
    v_mov_b32_dpp v31, v28 row_shl:6 row_mask:0xf bank_mask:0xf
    s_mov_b64 exec, 2
    v_min_u32 v28, 0xfffffffe, v26
    v_min_u32 v29, 0xfffffffe, v27
    s_mov_b64 exec, s[52:53]
    global_store_dwordx4 v124, v[28:31], s[34:35] sc1
    s_mov_b64 exec, -1
    s_cmp_lg_u32 s3, 15
    s_cbranch_scc1 L_bc_nohint
    s_lshl_b32 s45, s47, 6
    s_add_u32 s45, s45, 0x1f8000
    v_mov_b32 v8, s45
    v_mov_b32 v9, s43
    s_mov_b64 exec, 1
    global_store_dword v8, v9, s[34:35]
    s_mov_b64 exec, -1
L_bc_nohint:
    s_barrier
    s_cmp_ge_u32 s3, 8
    s_cbranch_scc1 L_bc_nomo
    s_cmp_ge_u32 s49, 28
    s_cbranch_scc1 L_mlq_19_done
    s_lshl_b32 s45, s49, 10
    s_and_b32 s46, s7, 3
    s_lshl_b32 s46, s46, 6
    s_add_u32 s45, s45, s46
    s_add_u32 s45, s45, 0xa000
    v_lshrrev_b32 v72, 2, v3
    v_lshlrev_b32 v72, 8, v72
    v_and_b32 v73, 3, v3
    v_lshl_add_u32 v72, v73, 4, v72
    v_add_u32 v72, s45, v72
    v_lshlrev_b32 v73, 3, v73
    ds_read_b64 v[74:75], v73 offset:7680
    global_load_dwordx4 v[88:91], v72, s[34:35] sc1
L_mlq_19_done:
    s_cmp_ge_u32 s49, 28
    s_cbranch_scc1 L_mlr_20_done
    s_mov_b32 s44, 0
    s_waitcnt vmcnt(0)
    s_branch Lpchk_22
Lpoll_21:
    s_and_b32 s45, s44, 15
    s_cmp_eq_u32 s45, 15
    s_cselect_b64 s[98:99], s[96:97], s[34:35]
    global_load_dwordx4 v[88:91], v72, s[98:99] sc1
    s_waitcnt vmcnt(0)
Lpchk_22:
    v_xor_b32 v112, v88, v120
    v_bitop3_b32 v112, v112, v89, v121 bitop3:0xf6
    v_bitop3_b32 v112, v112, v90, v122 bitop3:0xf6
    v_bitop3_b32 v112, v112, v91, v123 bitop3:0xf6
    v_and_b32 v112, 0xff, v112
    v_cmp_ne_u32 s[50:51], 0, v112
    s_add_u32 s44, s44, 1
    s_cmp_eq_u64 s[50:51], 0
    s_cbranch_scc1 Lpdone_23
    s_cmp_lt_u32 s44, 100000
    s_cbranch_scc1 Lpoll_21
    v_mov_b32 v112, 40
    v_mov_b32 v2, s2
    v_add_u32 v2, 0x10000, v2
    global_store_dword v112, v2, s[32:33]
Lpdone_23:
    s_waitcnt lgkmcnt(0)
    v_add_f32_dpp v88, v88, v88 row_ror:4 row_mask:0xf bank_mask:0xf
    v_add_f32_dpp v89, v89, v89 row_ror:4 row_mask:0xf bank_mask:0xf
    v_add_f32_dpp v90, v90, v90 row_ror:4 row_mask:0xf bank_mask:0xf
    v_add_f32_dpp v91, v91, v91 row_ror:4 row_mask:0xf bank_mask:0xf
    v_add_f32_dpp v88, v88, v88 row_ror:8 row_mask:0xf bank_mask:0xf
    v_add_f32_dpp v89, v89, v89 row_ror:8 row_mask:0xf bank_mask:0xf
    v_add_f32_dpp v90, v90, v90 row_ror:8 row_mask:0xf bank_mask:0xf
    v_add_f32_dpp v91, v91, v91 row_ror:8 row_mask:0xf bank_mask:0xf
    v_cvt_pk_bf16_f32 v92, v88, v89
    v_lshlrev_b32 v88, 16, v92
    v_and_b32 v89, 0xffff0000, v92
    v_cvt_pk_bf16_f32 v92, v90, v91
    v_lshlrev_b32 v90, 16, v92
    v_and_b32 v91, 0xffff0000, v92
    v_lshlrev_b32 v92, 16, v74
    v_and_b32 v93, 0xffff0000, v74
    v_lshlrev_b32 v94, 16, v75
    v_and_b32 v95, 0xffff0000, v75
    v_add_f32 v88, v88, v92
    v_add_f32 v89, v89, v93
    v_add_f32 v90, v90, v94
    v_add_f32 v91, v91, v95
    v_cvt_pk_bf16_f32 v92, v88, v89
    v_lshlrev_b32 v88, 16, v92
    v_and_b32 v89, 0xffff0000, v92
    v_cvt_pk_bf16_f32 v92, v90, v91
    v_lshlrev_b32 v90, 16, v92
    v_and_b32 v91, 0xffff0000, v92
    v_max_f32 v88, 0, v88
    v_max_f32 v89, 0, v89
    v_max_f32 v90, 0, v90
    v_max_f32 v91, 0, v91
    v_mul_f32 v88, v88, v88
    v_mul_f32 v89, v89, v89
    v_mul_f32 v90, v90, v90
    v_mul_f32 v91, v91, v91
    v_cvt_pk_bf16_f32 v92, v88, v89
    v_lshlrev_b32 v88, 16, v92
    v_and_b32 v89, 0xffff0000, v92
    v_cvt_pk_bf16_f32 v92, v90, v91
    v_lshlrev_b32 v90, 16, v92
    v_and_b32 v91, 0xffff0000, v92
    v_lshlrev_b32 v92, 1, v73
    ds_write_b128 v92, v[88:91] offset:7744
    s_waitcnt lgkmcnt(0)
L_mlr_20_done:
    s_cmp_ge_u32 s49, 28
    s_cbranch_scc1 L_mo_24_done
    v_lshrrev_b32 v92, 3, v1
    v_lshlrev_b32 v92, 2, v92
    ds_read_b32 v78, v92 offset:7744
    ds_read_b32 v79, v92 offset:7776
    v_lshlrev_b32 v88, 16, v32
    v_and_b32 v89, 0xffff0000, v32
    v_lshlrev_b32 v96, 16, v36
    v_and_b32 v97, 0xffff0000, v36
    v_lshlrev_b32 v90, 16, v33
    v_and_b32 v91, 0xffff0000, v33
    v_lshlrev_b32 v98, 16, v37
    v_and_b32 v99, 0xffff0000, v37
    v_lshlrev_b32 v92, 16, v34
    v_and_b32 v93, 0xffff0000, v34
    v_lshlrev_b32 v100, 16, v38
    v_and_b32 v101, 0xffff0000, v38
    v_lshlrev_b32 v94, 16, v35
    v_and_b32 v95, 0xffff0000, v35
    v_lshlrev_b32 v102, 16, v39
    v_and_b32 v103, 0xffff0000, v39
    v_lshrrev_b32 v72, 1, v4
    v_lshlrev_b32 v72, 4, v72
    v_and_b32 v73, 7, v1
    v_lshl_add_u32 v72, v73, 5, v72
    s_mul_i32 s45, s6, 1792
    s_mul_i32 s46, s3, 224
    s_add_u32 s45, s45, s46
    s_add_u32 s45, s45, 0x188000
    v_add_u32 v72, s45, v72
    s_mov_b32 s58, 0x7f
    s_mov_b32 s59, 0x7f
    s_waitcnt lgkmcnt(0)
    v_mul_f32 v88, v78, v88
    v_mul_f32 v89, v78, v89
    v_mul_f32 v90, v78, v90
    v_mul_f32 v91, v78, v91
    v_mul_f32 v92, v78, v92
    v_mul_f32 v93, v78, v93
    v_mul_f32 v94, v78, v94
    v_mul_f32 v95, v78, v95
    v_fmac_f32 v88, v79, v96
    v_fmac_f32 v89, v79, v97
    v_fmac_f32 v90, v79, v98
    v_fmac_f32 v91, v79, v99
    v_fmac_f32 v92, v79, v100
    v_fmac_f32 v93, v79, v101
    v_fmac_f32 v94, v79, v102
    v_fmac_f32 v95, v79, v103
    v_permlane32_swap_b32 v88, v92
    v_permlane32_swap_b32 v89, v93
    v_permlane32_swap_b32 v90, v94
    v_permlane32_swap_b32 v91, v95
    v_add_f32 v88, v88, v92
    v_add_f32 v89, v89, v93
    v_add_f32 v90, v90, v94
    v_add_f32 v91, v91, v95
    v_mov_b32 v92, v88
    v_mov_b32 v93, v89
    v_mov_b32 v94, v90
    v_mov_b32 v95, v91
    s_nop 0
    v_permlane16_swap_b32 v88, v92
    v_permlane16_swap_b32 v89, v93
    v_permlane16_swap_b32 v90, v94
    v_permlane16_swap_b32 v91, v95
    v_add_f32 v88, v88, v92
    v_add_f32 v89, v89, v93
    v_add_f32 v90, v90, v94
    v_add_f32 v91, v91, v95
    v_add_f32_dpp v88, v88, v88 row_ror:8 row_mask:0xf bank_mask:0xf
    v_add_f32_dpp v89, v89, v89 row_ror:8 row_mask:0xf bank_mask:0xf
    v_add_f32_dpp v90, v90, v90 row_ror:8 row_mask:0xf bank_mask:0xf
    v_add_f32_dpp v91, v91, v91 row_ror:8 row_mask:0xf bank_mask:0xf
    v_bfi_b32 v96, s38, v120, v88
    v_bfi_b32 v97, s38, v121, v89
    v_bfi_b32 v98, s38, v122, v90
    v_bfi_b32 v99, s38, v123, v91
    s_mov_b64 exec, s[58:59]
    global_store_dwordx4 v72, v[96:99], s[34:35] sc1
    s_mov_b64 exec, -1
L_mo_24_done:
L_bc_nomo:
    s_cmp_eq_u32 s3, 15
    s_cbranch_scc1 L_bc_fin
    s_branch L_bc_end
L_bc_fin:
    s_cmp_ge_u32 s7, 14
    s_cbranch_scc1 L_bc_end
    s_lshl_b32 s45, s55, 3
    v_lshlrev_b32 v7, 1, v4
    v_add_u32 v7, s45, v7
    global_load_ushort v60, v7, s[28:29]
    global_load_ushort v61, v7, s[8:9]
    s_lshl_b32 s45, s55, 4
    v_mul_u32_u24 v5, 1792, v1
    v_add_u32 v5, s45, v5
    v_mov_b32 v12, 0
    v_mov_b32 v13, 0
    v_mov_b32 v14, 0
    v_mov_b32 v15, 0
    s_mov_b32 s52, 0xffffffff
    s_mov_b32 s53, 0xffff
    v_add_u32 v40, 0x188000, v5
    v_add_u32 v41, 0x1a4000, v5
    v_add_u32 v42, 0x1c0000, v5
    v_add_u32 v43, 0x1dc000, v5
    s_mov_b32 s44, 0
Lpoll_25:
    global_load_dwordx4 v[8:11], v40, s[34:35] sc1
    s_mov_b64 exec, s[52:53]
    global_load_dwordx4 v[12:15], v41, s[34:35] sc1
    s_mov_b64 exec, -1
    s_waitcnt vmcnt(0)
    v_xor_b32 v112, v8, v120
    v_bitop3_b32 v112, v112, v9, v121 bitop3:0xf6
    v_bitop3_b32 v112, v112, v10, v122 bitop3:0xf6
    v_bitop3_b32 v112, v112, v11, v123 bitop3:0xf6
    s_mov_b64 exec, s[52:53]
    v_bitop3_b32 v112, v112, v12, v120 bitop3:0xf6
    v_bitop3_b32 v112, v112, v13, v121 bitop3:0xf6
    v_bitop3_b32 v112, v112, v14, v122 bitop3:0xf6
    v_bitop3_b32 v112, v112, v15, v123 bitop3:0xf6
    s_mov_b64 exec, -1
    v_and_b32 v112, 0xff, v112
    v_cmp_ne_u32 s[50:51], 0, v112
    s_mov_b64 exec, -1
    s_cmp_eq_u64 s[50:51], 0
    s_cbranch_scc1 Lpdone_26
    s_add_u32 s44, s44, 1
    s_cmp_lt_u32 s44, 100000
    s_cbranch_scc1 Lpoll_25
    v_mov_b32 v112, 24
    v_mov_b32 v2, s2
    v_add_u32 v2, 0x10000, v2
    global_store_dword v112, v2, s[32:33]
Lpdone_26:
    v_add_f32 v8, v8, v12
    v_add_f32 v9, v9, v13
    v_add_f32 v10, v10, v14
    v_add_f32 v11, v11, v15
    s_nop 1
    v_permlane32_swap_b32 v8, v10
    v_permlane32_swap_b32 v9, v11
    s_nop 1
    v_add_f32 v8, v8, v10
    v_add_f32 v9, v9, v11
    s_nop 1
    v_permlane16_swap_b32 v8, v9
    s_nop 1
    v_add_f32 v8, v8, v9
    s_nop 1
    v_add_f32_dpp v8, v8, v8 row_ror:8 row_mask:0xf bank_mask:0xf
    s_nop 1
    v_add_f32_dpp v8, v8, v8 row_ror:4 row_mask:0xf bank_mask:0xf
    s_nop 1
    v_add_f32_dpp v8, v8, v8 row_ror:2 row_mask:0xf bank_mask:0xf
    s_nop 1
    v_add_f32_dpp v8, v8, v8 row_ror:1 row_mask:0xf bank_mask:0xf
    v_cvt_pk_bf16_f32 v9, v8, v8
    v_lshlrev_b32 v8, 16, v9
    v_lshlrev_b32 v60, 16, v60
    v_lshlrev_b32 v61, 16, v61
    v_add_f32 v8, v8, v60
    v_cvt_pk_bf16_f32 v9, v8, v8
    v_lshlrev_b32 v8, 16, v9
    v_mul_f32 v9, 0xbfb8aa3b, v8
    v_exp_f32 v9, v9
    s_nop 0
    v_add_f32 v9, 1.0, v9
    v_rcp_f32 v9, v9
    s_nop 0
    v_mul_f32 v62, v8, v9
    v_cvt_pk_bf16_f32 v9, v62, v62
    v_lshlrev_b32 v62, 16, v9
    s_mov_b32 s52, 0x10001
    s_mov_b32 s53, 0x10001
    s_lshl_b32 s45, s47, 6
    s_add_u32 s45, s45, 0x1fa000
    v_mov_b32 v10, s45
    s_mov_b32 s44, 0
    s_mov_b64 exec, 1
Lhint_27:
    global_load_dword v11, v10, s[34:35] sc1
    s_waitcnt vmcnt(0)
    v_readfirstlane_b32 s45, v11
    s_add_u32 s44, s44, 1
    s_cmp_eq_u32 s45, s43
    s_cbranch_scc1 Lhint_27_d
    s_cmp_lt_u32 s44, 40
    s_cbranch_scc1 Lhint_27
Lhint_27_d:
    s_mov_b64 exec, -1
    global_load_dwordx4 v[24:27], v42, s[34:35] sc1
    global_load_dwordx4 v[28:31], v43, s[34:35] sc1
    s_mov_b32 s44, 0
    s_waitcnt vmcnt(0)
    s_branch Lpchk_29
Lpoll_28:
    global_load_dwordx4 v[24:27], v42, s[34:35] sc1
    global_load_dwordx4 v[28:31], v43, s[34:35] sc1
    s_waitcnt vmcnt(0)
Lpchk_29:
    v_xor_b32 v112, v24, v120
    v_bitop3_b32 v112, v112, v25, v121 bitop3:0xf6
    v_bitop3_b32 v112, v112, v26, v122 bitop3:0xf6
    v_bitop3_b32 v112, v112, v27, v123 bitop3:0xf6
    v_bitop3_b32 v112, v112, v28, v120 bitop3:0xf6
    v_bitop3_b32 v112, v112, v29, v121 bitop3:0xf6
    v_bitop3_b32 v112, v112, v30, v122 bitop3:0xf6
    v_bitop3_b32 v112, v112, v31, v123 bitop3:0xf6
    v_and_b32 v112, 0xff, v112
    v_cmp_ne_u32 s[50:51], 0, v112
    s_add_u32 s44, s44, 1
    s_cmp_eq_u64 s[50:51], 0
    s_cbranch_scc1 Lpdone_30
    s_cmp_lt_u32 s44, 100000
    s_cbranch_scc1 Lpoll_28
    v_mov_b32 v112, 28
    v_mov_b32 v2, s2
    v_add_u32 v2, 0x10000, v2
    global_store_dword v112, v2, s[32:33]
Lpdone_30:
    v_add_f32 v24, v24, v28
    v_add_f32 v25, v25, v29
    v_add_f32 v26, v26, v30
    v_add_f32 v27, v27, v31
    s_nop 1
    v_permlane32_swap_b32 v24, v26
    v_permlane32_swap_b32 v25, v27
    s_nop 1
    v_add_f32 v24, v24, v26
    v_add_f32 v25, v25, v27
    s_nop 1
    v_permlane16_swap_b32 v24, v25
    s_nop 1
    v_add_f32 v24, v24, v25
    s_nop 1
    v_add_f32_dpp v24, v24, v24 row_ror:8 row_mask:0xf bank_mask:0xf
    s_nop 1
    v_add_f32_dpp v24, v24, v24 row_ror:4 row_mask:0xf bank_mask:0xf
    s_nop 1
    v_add_f32_dpp v24, v24, v24 row_ror:2 row_mask:0xf bank_mask:0xf
    s_nop 1
    v_add_f32_dpp v24, v24, v24 row_ror:1 row_mask:0xf bank_mask:0xf
    v_cvt_pk_bf16_f32 v9, v24, v24
    v_lshlrev_b32 v24, 16, v9
    v_mul_f32 v24, v24, v62
    v_cvt_pk_bf16_f32 v9, v24, v24
    v_lshlrev_b32 v24, 16, v9
    v_add_f32 v24, v61, v24
    v_cvt_pk_bf16_f32 v24, v24, v24
    s_mov_b64 exec, s[52:53]
    global_store_short v7, v24, s[30:31]
    s_mov_b64 exec, -1
    s_cmp_lg_u32 s55, 0
    s_cbranch_scc1 L_bc_end
    v_mov_b32 v5, 0
    v_mov_b32 v6, s43
    s_mov_b64 exec, 1
    global_store_dword v5, v6, s[34:35] sc1
    s_mov_b64 exec, -1
L_bc_end:
    s_endpgm
L_end:
    s_endpgm
L_code_end:
.section .rodata,"a"
.p2align 6
.amdhsa_kernel recurrent_scan__compressed_kv_cla__dense_activation_squared_relu__decode_kernel
  .amdhsa_next_free_vgpr 128
  .amdhsa_next_free_sgpr 100
  .amdhsa_accum_offset 128
  .amdhsa_group_segment_fixed_size 0
  .amdhsa_kernarg_size 112
  .amdhsa_user_sgpr_count 2
  .amdhsa_user_sgpr_kernarg_segment_ptr 1
  .amdhsa_system_sgpr_workgroup_id_x 1
  .amdhsa_float_denorm_mode_32 3
.end_amdhsa_kernel
```
